```python
import torch

def _softmax(x, axis=-1):
    return torch.softmax(x, dim=axis)

def _gelu(x):
    return torch.nn.functional.gelu(x, approximate='tanh')

def _silu(x):
    return torch.nn.functional.silu(x)

def _sigmoid(x):
    return torch.sigmoid(x)

def _layernorm(x, axis=-1, eps=1e-05):
    m = x.mean(dim=axis, keepdim=True)
    v = x.var(dim=axis, keepdim=True, unbiased=False)
    return (x - m) / torch.sqrt(v + eps)

def _scatter_add(tgt, idx, src, axis=0):
    return tgt.clone().index_add_(axis, idx, src)

def _segment_sum(src, seg, n):
    out = torch.zeros((n,) + src.shape[1:], dtype=src.dtype)
    return out.index_add_(0, seg, src)

def _pad(x, pw):
    flat = tuple((v for pair in reversed(pw) for v in pair))
    return torch.nn.functional.pad(x, flat)
kernel_name = 'sequential_preLN__sliding_block__mixer_gmlp__prompt'

def setup_inputs():

    _w = lambda a: (lambda t: t.to(torch.bfloat16) if t.is_floating_point() else t)(torch.as_tensor(a))

    def _A_setup():
        B, S, D = (1, 2048, 512)
        return {'x': _w((lambda *s: torch.randn(*s, dtype=torch.bfloat16) * 0.05)(B, S, D)), 'wqkv': _w((lambda *s: torch.randn(*s, dtype=torch.bfloat16) * 0.05)(D, 3 * D)), 'wo': _w((lambda *s: torch.randn(*s, dtype=torch.bfloat16) * 0.05)(D, D))}
    _A_in = _A_setup()

    def _B_setup():
        B, S, D, F = (1, 2048, 512, 1792)
        Fh = F // 2
        return {'x': _w((lambda *s: torch.randn(*s, dtype=torch.bfloat16) * 0.05)(B, S, D)), 'w_in': _w((lambda *s: torch.randn(*s, dtype=torch.bfloat16) * 0.4)(D, 2 * Fh)), 'w_sp': _w(0.01 * (lambda *s: torch.randn(*s, dtype=torch.bfloat16) * 0.4)(S, S)), 'b_sp': _w(1.0 + 0.01 * (lambda *s: torch.randn(*s, dtype=torch.bfloat16) * 0.05)(S)), 'w_out': _w((lambda *s: torch.randn(*s, dtype=torch.bfloat16) * 0.05)(Fh, D))}
    _B_in = _B_setup()
    return {'A_x': _A_in['x'], 'A_wqkv': _A_in['wqkv'], 'A_wo': _A_in['wo'], 'B_x': _B_in['x'], 'B_w_in': _B_in['w_in'], 'B_w_sp': _B_in['w_sp'], 'B_b_sp': _B_in['b_sp'], 'B_w_out': _B_in['w_out']}

def reference(A_x, A_wqkv, A_wo, B_x, B_w_in, B_w_sp, B_b_sp, B_w_out):

    def _A_ref(x, wqkv, wo):
        B, S, D = x.shape
        H = 32
        Dh = D // H
        W = 256
        qkv = (lambda x, *d: x.permute(*d))((x @ wqkv).reshape(B, S, 3, H, Dh), 2, 0, 3, 1, 4)
        q, k, v = (qkv[0], qkv[1], qkv[2])
        scores = torch.einsum('bhqd,bhkd->bhqk', q, k) * Dh ** (-0.5)
        idx = torch.arange(S)
        mask = (idx[:, None] - idx[None, :] >= 0) & (idx[:, None] - idx[None, :] < W)
        scores = torch.where(mask[None, None], scores, -1000000000.0)
        p = _softmax(scores, axis=-1)
        o = torch.einsum('bhqk,bhkd->bhqd', p, v)
        return (lambda x, *d: x.permute(*d))(o, 0, 2, 1, 3).reshape(B, S, D) @ wo

    def _B_ref(x, w_in, w_sp, b_sp, w_out):
        B, S, D = x.shape
        F = w_in.shape[-1]
        Fh = F // 2
        z = _gelu(torch.einsum('bsd,df->bsf', x, w_in))
        z1 = z[..., :Fh].clone()
        z2 = _layernorm(z[..., Fh:], axis=-1)
        g = torch.einsum('ts,bsf->btf', w_sp, z2) + b_sp[None, :, None]
        return torch.einsum('bsf,fd->bsd', z1 * g, w_out)
    x = A_x
    h = x + _A_ref(_layernorm(x, axis=-1), A_wqkv, A_wo)
    h2 = h + _B_ref(_layernorm(h, axis=-1), B_w_in, B_w_sp, B_b_sp, B_w_out)
    return h2
```

```asm
; @launch kernel=k1_qkv_kernel grid=(256,1,1) block=(512,1,1) lds=118784
; @launch kernel=k2_attn_kernel grid=(1024,1,1) block=(256,1,1) lds=0
; @launch kernel=k3_wo_kernel grid=(256,1,1) block=(512,1,1) lds=36864
; @launch kernel=k4_win_kernel grid=(256,1,1) block=(512,1,1) lds=126976
; @launch kernel=k5_lnt_kernel grid=(128,1,1) block=(256,1,1) lds=29184
; @launch kernel=k6_wsp_kernel grid=(224,1,1) block=(512,1,1) lds=49152
; @launch kernel=k7_wout_kernel grid=(256,1,1) block=(512,1,1) lds=36864
.amdgcn_target "amdgcn-amd-amdhsa--gfx950"
.text
.p2align 8
.globl k1_qkv_kernel
.type k1_qkv_kernel,@function
k1_qkv_kernel:
    s_cmp_ge_u32 s2, 256
    s_cbranch_scc1 k1_qkv_kernel_end
    s_load_dwordx2 s[4:5], s[0:1], 0
    s_load_dwordx2 s[6:7], s[0:1], 8
    s_load_dwordx2 s[8:9], s[0:1], 80
    s_lshr_b32 s28, s2, 3
    s_lshl_b32 s28, s28, 6
    s_and_b32 s29, s2, 7
    s_mul_i32 s29, s29, 192
    v_and_b32 v1, 63, v0
    v_lshrrev_b32 v2, 6, v0
    s_nop 0
    v_readfirstlane_b32 s30, v2
    s_waitcnt lgkmcnt(0)
    s_mov_b32 s12, s4
    s_and_b32 s13, s5, 0xffff
    s_mov_b32 s14, 0x200000
    s_mov_b32 s15, 0x00020000
    s_mov_b32 s20, s8
    s_and_b32 s21, s9, 0xffff
    s_mov_b32 s22, 0x400000
    s_mov_b32 s23, 0x00020000
    s_add_u32 s24, s8, 0x400000
    s_addc_u32 s25, s9, 0
    s_and_b32 s25, s25, 0xffff
    s_mov_b32 s26, 0x200000
    s_mov_b32 s27, 0x00020000
    s_mov_b32 s16, s6
    s_and_b32 s17, s7, 0xffff
    s_mov_b32 s18, 0x180000
    s_mov_b32 s19, 0x00020000
    s_mov_b32 s48, 512
    s_mov_b32 s32, 2731
    s_lshl_b32 s33, s29, 1
    v_add_u32 v3, 0, v0
    v_mul_u32_u24 v4, s32, v3
    v_lshrrev_b32 v4, 16, v4
    v_mul_u32_u24 v5, 24, v4
    v_sub_u32 v5, v3, v5
    v_lshlrev_b32 v5, 4, v5
    s_mov_b32 s34, 3072
    v_mul_u32_u24 v8, s34, v4
    v_add3_u32 v8, v8, v5, s33
    v_bfe_u32 v6, v4, 2, 1
    v_bfe_u32 v7, v4, 3, 1
    v_and_b32 v4, 0xfffffff3, v4
    v_lshl_or_b32 v4, v6, 3, v4
    v_lshl_or_b32 v4, v7, 2, v4
    s_mov_b32 s34, 416
    v_mul_u32_u24 v16, s34, v4
    v_add_u32 v16, v16, v5
    v_add_u32 v16, 65536, v16
    v_add_u32 v3, 512, v0
    v_mul_u32_u24 v4, s32, v3
    v_lshrrev_b32 v4, 16, v4
    v_mul_u32_u24 v5, 24, v4
    v_sub_u32 v5, v3, v5
    v_lshlrev_b32 v5, 4, v5
    s_mov_b32 s34, 3072
    v_mul_u32_u24 v9, s34, v4
    v_add3_u32 v9, v9, v5, s33
    v_bfe_u32 v6, v4, 2, 1
    v_bfe_u32 v7, v4, 3, 1
    v_and_b32 v4, 0xfffffff3, v4
    v_lshl_or_b32 v4, v6, 3, v4
    v_lshl_or_b32 v4, v7, 2, v4
    s_mov_b32 s34, 416
    v_mul_u32_u24 v17, s34, v4
    v_add_u32 v17, v17, v5
    v_add_u32 v17, 65536, v17
    v_add_u32 v3, 1024, v0
    v_mul_u32_u24 v4, s32, v3
    v_lshrrev_b32 v4, 16, v4
    v_mul_u32_u24 v5, 24, v4
    v_sub_u32 v5, v3, v5
    v_lshlrev_b32 v5, 4, v5
    s_mov_b32 s34, 3072
    v_mul_u32_u24 v10, s34, v4
    v_add3_u32 v10, v10, v5, s33
    v_bfe_u32 v6, v4, 2, 1
    v_bfe_u32 v7, v4, 3, 1
    v_and_b32 v4, 0xfffffff3, v4
    v_lshl_or_b32 v4, v6, 3, v4
    v_lshl_or_b32 v4, v7, 2, v4
    s_mov_b32 s34, 416
    v_mul_u32_u24 v18, s34, v4
    v_add_u32 v18, v18, v5
    v_add_u32 v18, 65536, v18
    v_cmp_gt_u32 s[46:47], s48, v0
    s_mov_b32 s35, 0
    buffer_load_dwordx4 v[184:187], v8, s[16:19], s35 offen
    buffer_load_dwordx4 v[188:191], v9, s[16:19], s35 offen
    buffer_load_dwordx4 v[192:195], v10, s[16:19], s35 offen
    s_mov_b32 s35, 196608
    buffer_load_dwordx4 v[212:215], v8, s[16:19], s35 offen
    buffer_load_dwordx4 v[216:219], v9, s[16:19], s35 offen
    buffer_load_dwordx4 v[220:223], v10, s[16:19], s35 offen
    v_lshrrev_b32 v3, 3, v0
    v_and_b32 v4, 7, v0
    v_add_u32 v5, s28, v3
    v_lshlrev_b32 v5, 10, v5
    v_lshl_add_u32 v5, v4, 4, v5
    buffer_load_dwordx4 v[64:67], v5, s[12:15], 0 offen offset:0
    buffer_load_dwordx4 v[68:71], v5, s[12:15], 0 offen offset:128
    buffer_load_dwordx4 v[72:75], v5, s[12:15], 0 offen offset:256
    buffer_load_dwordx4 v[76:79], v5, s[12:15], 0 offen offset:384
    buffer_load_dwordx4 v[80:83], v5, s[12:15], 0 offen offset:512
    buffer_load_dwordx4 v[84:87], v5, s[12:15], 0 offen offset:640
    buffer_load_dwordx4 v[88:91], v5, s[12:15], 0 offen offset:768
    buffer_load_dwordx4 v[92:95], v5, s[12:15], 0 offen offset:896
    s_mov_b32 s36, 0x3f803f80
    v_mov_b32 v24, 0
    v_mov_b32 v25, 0
    v_mov_b32 v26, 0
    v_mov_b32 v27, 0
    s_waitcnt vmcnt(0)
    v_lshlrev_b32 v28, 16, v64
    v_and_b32 v29, 0xffff0000, v64
    v_add_f32 v24, v24, v28
    v_add_f32 v25, v25, v29
    v_fma_f32 v26, v28, v28, v26
    v_fma_f32 v27, v29, v29, v27
    v_lshlrev_b32 v28, 16, v65
    v_and_b32 v29, 0xffff0000, v65
    v_add_f32 v24, v24, v28
    v_add_f32 v25, v25, v29
    v_fma_f32 v26, v28, v28, v26
    v_fma_f32 v27, v29, v29, v27
    v_lshlrev_b32 v28, 16, v66
    v_and_b32 v29, 0xffff0000, v66
    v_add_f32 v24, v24, v28
    v_add_f32 v25, v25, v29
    v_fma_f32 v26, v28, v28, v26
    v_fma_f32 v27, v29, v29, v27
    v_lshlrev_b32 v28, 16, v67
    v_and_b32 v29, 0xffff0000, v67
    v_add_f32 v24, v24, v28
    v_add_f32 v25, v25, v29
    v_fma_f32 v26, v28, v28, v26
    v_fma_f32 v27, v29, v29, v27
    v_lshlrev_b32 v28, 16, v68
    v_and_b32 v29, 0xffff0000, v68
    v_add_f32 v24, v24, v28
    v_add_f32 v25, v25, v29
    v_fma_f32 v26, v28, v28, v26
    v_fma_f32 v27, v29, v29, v27
    v_lshlrev_b32 v28, 16, v69
    v_and_b32 v29, 0xffff0000, v69
    v_add_f32 v24, v24, v28
    v_add_f32 v25, v25, v29
    v_fma_f32 v26, v28, v28, v26
    v_fma_f32 v27, v29, v29, v27
    v_lshlrev_b32 v28, 16, v70
    v_and_b32 v29, 0xffff0000, v70
    v_add_f32 v24, v24, v28
    v_add_f32 v25, v25, v29
    v_fma_f32 v26, v28, v28, v26
    v_fma_f32 v27, v29, v29, v27
    v_lshlrev_b32 v28, 16, v71
    v_and_b32 v29, 0xffff0000, v71
    v_add_f32 v24, v24, v28
    v_add_f32 v25, v25, v29
    v_fma_f32 v26, v28, v28, v26
    v_fma_f32 v27, v29, v29, v27
    v_lshlrev_b32 v28, 16, v72
    v_and_b32 v29, 0xffff0000, v72
    v_add_f32 v24, v24, v28
    v_add_f32 v25, v25, v29
    v_fma_f32 v26, v28, v28, v26
    v_fma_f32 v27, v29, v29, v27
    v_lshlrev_b32 v28, 16, v73
    v_and_b32 v29, 0xffff0000, v73
    v_add_f32 v24, v24, v28
    v_add_f32 v25, v25, v29
    v_fma_f32 v26, v28, v28, v26
    v_fma_f32 v27, v29, v29, v27
    v_lshlrev_b32 v28, 16, v74
    v_and_b32 v29, 0xffff0000, v74
    v_add_f32 v24, v24, v28
    v_add_f32 v25, v25, v29
    v_fma_f32 v26, v28, v28, v26
    v_fma_f32 v27, v29, v29, v27
    v_lshlrev_b32 v28, 16, v75
    v_and_b32 v29, 0xffff0000, v75
    v_add_f32 v24, v24, v28
    v_add_f32 v25, v25, v29
    v_fma_f32 v26, v28, v28, v26
    v_fma_f32 v27, v29, v29, v27
    v_lshlrev_b32 v28, 16, v76
    v_and_b32 v29, 0xffff0000, v76
    v_add_f32 v24, v24, v28
    v_add_f32 v25, v25, v29
    v_fma_f32 v26, v28, v28, v26
    v_fma_f32 v27, v29, v29, v27
    v_lshlrev_b32 v28, 16, v77
    v_and_b32 v29, 0xffff0000, v77
    v_add_f32 v24, v24, v28
    v_add_f32 v25, v25, v29
    v_fma_f32 v26, v28, v28, v26
    v_fma_f32 v27, v29, v29, v27
    v_lshlrev_b32 v28, 16, v78
    v_and_b32 v29, 0xffff0000, v78
    v_add_f32 v24, v24, v28
    v_add_f32 v25, v25, v29
    v_fma_f32 v26, v28, v28, v26
    v_fma_f32 v27, v29, v29, v27
    v_lshlrev_b32 v28, 16, v79
    v_and_b32 v29, 0xffff0000, v79
    v_add_f32 v24, v24, v28
    v_add_f32 v25, v25, v29
    v_fma_f32 v26, v28, v28, v26
    v_fma_f32 v27, v29, v29, v27
    v_lshlrev_b32 v28, 16, v80
    v_and_b32 v29, 0xffff0000, v80
    v_add_f32 v24, v24, v28
    v_add_f32 v25, v25, v29
    v_fma_f32 v26, v28, v28, v26
    v_fma_f32 v27, v29, v29, v27
    v_lshlrev_b32 v28, 16, v81
    v_and_b32 v29, 0xffff0000, v81
    v_add_f32 v24, v24, v28
    v_add_f32 v25, v25, v29
    v_fma_f32 v26, v28, v28, v26
    v_fma_f32 v27, v29, v29, v27
    v_lshlrev_b32 v28, 16, v82
    v_and_b32 v29, 0xffff0000, v82
    v_add_f32 v24, v24, v28
    v_add_f32 v25, v25, v29
    v_fma_f32 v26, v28, v28, v26
    v_fma_f32 v27, v29, v29, v27
    v_lshlrev_b32 v28, 16, v83
    v_and_b32 v29, 0xffff0000, v83
    v_add_f32 v24, v24, v28
    v_add_f32 v25, v25, v29
    v_fma_f32 v26, v28, v28, v26
    v_fma_f32 v27, v29, v29, v27
    v_lshlrev_b32 v28, 16, v84
    v_and_b32 v29, 0xffff0000, v84
    v_add_f32 v24, v24, v28
    v_add_f32 v25, v25, v29
    v_fma_f32 v26, v28, v28, v26
    v_fma_f32 v27, v29, v29, v27
    v_lshlrev_b32 v28, 16, v85
    v_and_b32 v29, 0xffff0000, v85
    v_add_f32 v24, v24, v28
    v_add_f32 v25, v25, v29
    v_fma_f32 v26, v28, v28, v26
    v_fma_f32 v27, v29, v29, v27
    v_lshlrev_b32 v28, 16, v86
    v_and_b32 v29, 0xffff0000, v86
    v_add_f32 v24, v24, v28
    v_add_f32 v25, v25, v29
    v_fma_f32 v26, v28, v28, v26
    v_fma_f32 v27, v29, v29, v27
    v_lshlrev_b32 v28, 16, v87
    v_and_b32 v29, 0xffff0000, v87
    v_add_f32 v24, v24, v28
    v_add_f32 v25, v25, v29
    v_fma_f32 v26, v28, v28, v26
    v_fma_f32 v27, v29, v29, v27
    v_lshlrev_b32 v28, 16, v88
    v_and_b32 v29, 0xffff0000, v88
    v_add_f32 v24, v24, v28
    v_add_f32 v25, v25, v29
    v_fma_f32 v26, v28, v28, v26
    v_fma_f32 v27, v29, v29, v27
    v_lshlrev_b32 v28, 16, v89
    v_and_b32 v29, 0xffff0000, v89
    v_add_f32 v24, v24, v28
    v_add_f32 v25, v25, v29
    v_fma_f32 v26, v28, v28, v26
    v_fma_f32 v27, v29, v29, v27
    v_lshlrev_b32 v28, 16, v90
    v_and_b32 v29, 0xffff0000, v90
    v_add_f32 v24, v24, v28
    v_add_f32 v25, v25, v29
    v_fma_f32 v26, v28, v28, v26
    v_fma_f32 v27, v29, v29, v27
    v_lshlrev_b32 v28, 16, v91
    v_and_b32 v29, 0xffff0000, v91
    v_add_f32 v24, v24, v28
    v_add_f32 v25, v25, v29
    v_fma_f32 v26, v28, v28, v26
    v_fma_f32 v27, v29, v29, v27
    v_lshlrev_b32 v28, 16, v92
    v_and_b32 v29, 0xffff0000, v92
    v_add_f32 v24, v24, v28
    v_add_f32 v25, v25, v29
    v_fma_f32 v26, v28, v28, v26
    v_fma_f32 v27, v29, v29, v27
    v_lshlrev_b32 v28, 16, v93
    v_and_b32 v29, 0xffff0000, v93
    v_add_f32 v24, v24, v28
    v_add_f32 v25, v25, v29
    v_fma_f32 v26, v28, v28, v26
    v_fma_f32 v27, v29, v29, v27
    v_lshlrev_b32 v28, 16, v94
    v_and_b32 v29, 0xffff0000, v94
    v_add_f32 v24, v24, v28
    v_add_f32 v25, v25, v29
    v_fma_f32 v26, v28, v28, v26
    v_fma_f32 v27, v29, v29, v27
    v_lshlrev_b32 v28, 16, v95
    v_and_b32 v29, 0xffff0000, v95
    v_add_f32 v24, v24, v28
    v_add_f32 v25, v25, v29
    v_fma_f32 v26, v28, v28, v26
    v_fma_f32 v27, v29, v29, v27
    v_add_f32 v24, v24, v25
    v_add_f32 v26, v26, v27
    s_nop 0
    v_add_f32_dpp v24, v24, v24 quad_perm:[1,0,3,2] row_mask:0xf bank_mask:0xf
    v_add_f32_dpp v26, v26, v26 quad_perm:[1,0,3,2] row_mask:0xf bank_mask:0xf
    s_nop 0
    v_add_f32_dpp v24, v24, v24 quad_perm:[2,3,0,1] row_mask:0xf bank_mask:0xf
    v_add_f32_dpp v26, v26, v26 quad_perm:[2,3,0,1] row_mask:0xf bank_mask:0xf
    s_nop 0
    v_add_f32_dpp v24, v24, v24 row_half_mirror row_mask:0xf bank_mask:0xf
    v_add_f32_dpp v26, v26, v26 row_half_mirror row_mask:0xf bank_mask:0xf
    v_mul_f32 v24, 0x3b000000, v24
    v_mul_f32 v26, 0x3b000000, v26
    v_fma_f32 v26, -v24, v24, v26
    v_max_f32 v26, 0, v26
    v_cvt_pk_bf16_f32 v24, v24, v24
    v_lshlrev_b32 v24, 16, v24
    v_cvt_pk_bf16_f32 v26, v26, v26
    v_lshlrev_b32 v26, 16, v26
    v_add_f32 v26, 0x3727c5ac, v26
    v_cvt_pk_bf16_f32 v26, v26, v26
    v_lshlrev_b32 v26, 16, v26
    v_sqrt_f32 v26, v26
    s_nop 0
    v_cvt_pk_bf16_f32 v26, v26, v26
    v_lshlrev_b32 v26, 16, v26
    v_rcp_f32 v26, v26
    s_nop 0
    v_mul_f32 v24, v24, v26
    v_sub_f32 v24, 0, v24
    v_and_b32 v6, 15, v3
    v_lshlrev_b32 v7, 10, v3
    v_add_u32 v28, 0, v4
    v_xor_b32 v28, v28, v6
    v_lshl_add_u32 v28, v28, 4, v7
    v_add_u32 v29, 8, v4
    v_xor_b32 v29, v29, v6
    v_lshl_add_u32 v29, v29, 4, v7
    v_lshlrev_b32 v32, 16, v64
    v_and_b32 v33, 0xffff0000, v64
    v_fma_f32 v32, v32, v26, v24
    v_fma_f32 v33, v33, v26, v24
    v_cvt_pk_bf16_f32 v64, v32, v33
    v_lshlrev_b32 v32, 16, v65
    v_and_b32 v33, 0xffff0000, v65
    v_fma_f32 v32, v32, v26, v24
    v_fma_f32 v33, v33, v26, v24
    v_cvt_pk_bf16_f32 v65, v32, v33
    v_lshlrev_b32 v32, 16, v66
    v_and_b32 v33, 0xffff0000, v66
    v_fma_f32 v32, v32, v26, v24
    v_fma_f32 v33, v33, v26, v24
    v_cvt_pk_bf16_f32 v66, v32, v33
    v_lshlrev_b32 v32, 16, v67
    v_and_b32 v33, 0xffff0000, v67
    v_fma_f32 v32, v32, v26, v24
    v_fma_f32 v33, v33, v26, v24
    v_cvt_pk_bf16_f32 v67, v32, v33
    ds_write_b128 v28, v[64:67] offset:0
    v_lshlrev_b32 v32, 16, v68
    v_and_b32 v33, 0xffff0000, v68
    v_fma_f32 v32, v32, v26, v24
    v_fma_f32 v33, v33, v26, v24
    v_cvt_pk_bf16_f32 v68, v32, v33
    v_lshlrev_b32 v32, 16, v69
    v_and_b32 v33, 0xffff0000, v69
    v_fma_f32 v32, v32, v26, v24
    v_fma_f32 v33, v33, v26, v24
    v_cvt_pk_bf16_f32 v69, v32, v33
    v_lshlrev_b32 v32, 16, v70
    v_and_b32 v33, 0xffff0000, v70
    v_fma_f32 v32, v32, v26, v24
    v_fma_f32 v33, v33, v26, v24
    v_cvt_pk_bf16_f32 v70, v32, v33
    v_lshlrev_b32 v32, 16, v71
    v_and_b32 v33, 0xffff0000, v71
    v_fma_f32 v32, v32, v26, v24
    v_fma_f32 v33, v33, v26, v24
    v_cvt_pk_bf16_f32 v71, v32, v33
    ds_write_b128 v29, v[68:71] offset:0
    v_lshlrev_b32 v32, 16, v72
    v_and_b32 v33, 0xffff0000, v72
    v_fma_f32 v32, v32, v26, v24
    v_fma_f32 v33, v33, v26, v24
    v_cvt_pk_bf16_f32 v72, v32, v33
    v_lshlrev_b32 v32, 16, v73
    v_and_b32 v33, 0xffff0000, v73
    v_fma_f32 v32, v32, v26, v24
    v_fma_f32 v33, v33, v26, v24
    v_cvt_pk_bf16_f32 v73, v32, v33
    v_lshlrev_b32 v32, 16, v74
    v_and_b32 v33, 0xffff0000, v74
    v_fma_f32 v32, v32, v26, v24
    v_fma_f32 v33, v33, v26, v24
    v_cvt_pk_bf16_f32 v74, v32, v33
    v_lshlrev_b32 v32, 16, v75
    v_and_b32 v33, 0xffff0000, v75
    v_fma_f32 v32, v32, v26, v24
    v_fma_f32 v33, v33, v26, v24
    v_cvt_pk_bf16_f32 v75, v32, v33
    ds_write_b128 v28, v[72:75] offset:256
    v_lshlrev_b32 v32, 16, v76
    v_and_b32 v33, 0xffff0000, v76
    v_fma_f32 v32, v32, v26, v24
    v_fma_f32 v33, v33, v26, v24
    v_cvt_pk_bf16_f32 v76, v32, v33
    v_lshlrev_b32 v32, 16, v77
    v_and_b32 v33, 0xffff0000, v77
    v_fma_f32 v32, v32, v26, v24
    v_fma_f32 v33, v33, v26, v24
    v_cvt_pk_bf16_f32 v77, v32, v33
    v_lshlrev_b32 v32, 16, v78
    v_and_b32 v33, 0xffff0000, v78
    v_fma_f32 v32, v32, v26, v24
    v_fma_f32 v33, v33, v26, v24
    v_cvt_pk_bf16_f32 v78, v32, v33
    v_lshlrev_b32 v32, 16, v79
    v_and_b32 v33, 0xffff0000, v79
    v_fma_f32 v32, v32, v26, v24
    v_fma_f32 v33, v33, v26, v24
    v_cvt_pk_bf16_f32 v79, v32, v33
    ds_write_b128 v29, v[76:79] offset:256
    v_lshlrev_b32 v32, 16, v80
    v_and_b32 v33, 0xffff0000, v80
    v_fma_f32 v32, v32, v26, v24
    v_fma_f32 v33, v33, v26, v24
    v_cvt_pk_bf16_f32 v80, v32, v33
    v_lshlrev_b32 v32, 16, v81
    v_and_b32 v33, 0xffff0000, v81
    v_fma_f32 v32, v32, v26, v24
    v_fma_f32 v33, v33, v26, v24
    v_cvt_pk_bf16_f32 v81, v32, v33
    v_lshlrev_b32 v32, 16, v82
    v_and_b32 v33, 0xffff0000, v82
    v_fma_f32 v32, v32, v26, v24
    v_fma_f32 v33, v33, v26, v24
    v_cvt_pk_bf16_f32 v82, v32, v33
    v_lshlrev_b32 v32, 16, v83
    v_and_b32 v33, 0xffff0000, v83
    v_fma_f32 v32, v32, v26, v24
    v_fma_f32 v33, v33, v26, v24
    v_cvt_pk_bf16_f32 v83, v32, v33
    ds_write_b128 v28, v[80:83] offset:512
    v_lshlrev_b32 v32, 16, v84
    v_and_b32 v33, 0xffff0000, v84
    v_fma_f32 v32, v32, v26, v24
    v_fma_f32 v33, v33, v26, v24
    v_cvt_pk_bf16_f32 v84, v32, v33
    v_lshlrev_b32 v32, 16, v85
    v_and_b32 v33, 0xffff0000, v85
    v_fma_f32 v32, v32, v26, v24
    v_fma_f32 v33, v33, v26, v24
    v_cvt_pk_bf16_f32 v85, v32, v33
    v_lshlrev_b32 v32, 16, v86
    v_and_b32 v33, 0xffff0000, v86
    v_fma_f32 v32, v32, v26, v24
    v_fma_f32 v33, v33, v26, v24
    v_cvt_pk_bf16_f32 v86, v32, v33
    v_lshlrev_b32 v32, 16, v87
    v_and_b32 v33, 0xffff0000, v87
    v_fma_f32 v32, v32, v26, v24
    v_fma_f32 v33, v33, v26, v24
    v_cvt_pk_bf16_f32 v87, v32, v33
    ds_write_b128 v29, v[84:87] offset:512
    v_lshlrev_b32 v32, 16, v88
    v_and_b32 v33, 0xffff0000, v88
    v_fma_f32 v32, v32, v26, v24
    v_fma_f32 v33, v33, v26, v24
    v_cvt_pk_bf16_f32 v88, v32, v33
    v_lshlrev_b32 v32, 16, v89
    v_and_b32 v33, 0xffff0000, v89
    v_fma_f32 v32, v32, v26, v24
    v_fma_f32 v33, v33, v26, v24
    v_cvt_pk_bf16_f32 v89, v32, v33
    v_lshlrev_b32 v32, 16, v90
    v_and_b32 v33, 0xffff0000, v90
    v_fma_f32 v32, v32, v26, v24
    v_fma_f32 v33, v33, v26, v24
    v_cvt_pk_bf16_f32 v90, v32, v33
    v_lshlrev_b32 v32, 16, v91
    v_and_b32 v33, 0xffff0000, v91
    v_fma_f32 v32, v32, v26, v24
    v_fma_f32 v33, v33, v26, v24
    v_cvt_pk_bf16_f32 v91, v32, v33
    ds_write_b128 v28, v[88:91] offset:768
    v_lshlrev_b32 v32, 16, v92
    v_and_b32 v33, 0xffff0000, v92
    v_fma_f32 v32, v32, v26, v24
    v_fma_f32 v33, v33, v26, v24
    v_cvt_pk_bf16_f32 v92, v32, v33
    v_lshlrev_b32 v32, 16, v93
    v_and_b32 v33, 0xffff0000, v93
    v_fma_f32 v32, v32, v26, v24
    v_fma_f32 v33, v33, v26, v24
    v_cvt_pk_bf16_f32 v93, v32, v33
    v_lshlrev_b32 v32, 16, v94
    v_and_b32 v33, 0xffff0000, v94
    v_fma_f32 v32, v32, v26, v24
    v_fma_f32 v33, v33, v26, v24
    v_cvt_pk_bf16_f32 v94, v32, v33
    v_lshlrev_b32 v32, 16, v95
    v_and_b32 v33, 0xffff0000, v95
    v_fma_f32 v32, v32, v26, v24
    v_fma_f32 v33, v33, v26, v24
    v_cvt_pk_bf16_f32 v95, v32, v33
    ds_write_b128 v29, v[92:95] offset:768
    v_lshrrev_b32 v3, 4, v1
    v_and_b32 v4, 15, v1
    s_lshr_b32 s37, s30, 1
    s_lshl_b32 s37, s37, 14
    v_lshlrev_b32 v5, 10, v4
    v_add_u32 v5, s37, v5
    v_add_u32 v36, 0, v3
    v_xor_b32 v36, v36, v4
    v_lshl_add_u32 v36, v36, 4, v5
    v_add_u32 v37, 4, v3
    v_xor_b32 v37, v37, v4
    v_lshl_add_u32 v37, v37, 4, v5
    v_add_u32 v38, 8, v3
    v_xor_b32 v38, v38, v4
    v_lshl_add_u32 v38, v38, 4, v5
    v_add_u32 v39, 12, v3
    v_xor_b32 v39, v39, v4
    v_lshl_add_u32 v39, v39, 4, v5
    v_lshrrev_b32 v5, 1, v3
    v_lshlrev_b32 v5, 4, v5
    v_and_b32 v6, 1, v3
    v_lshl_add_u32 v5, v6, 2, v5
    v_lshrrev_b32 v6, 2, v4
    v_add_u32 v5, v5, v6
    s_mov_b32 s34, 416
    v_mul_u32_u24 v5, s34, v5
    v_and_b32 v6, 3, v4
    v_lshl_add_u32 v5, v6, 3, v5
    s_and_b32 s38, s30, 1
    s_mul_i32 s38, s38, 192
    s_add_u32 s38, s38, 65536
    v_add_u32 v40, s38, v5
    s_mov_b32 s35, 393216
    buffer_load_dwordx4 v[100:103], v8, s[16:19], s35 offen
    buffer_load_dwordx4 v[104:107], v9, s[16:19], s35 offen
    buffer_load_dwordx4 v[108:111], v10, s[16:19], s35 offen
    s_waitcnt vmcnt(6)
    ds_write_b128 v16, v[184:187] offset:0
    ds_write_b128 v17, v[188:191] offset:0
    ds_write_b128 v18, v[192:195] offset:0
    s_mov_b32 s35, 589824
    buffer_load_dwordx4 v[184:187], v8, s[16:19], s35 offen
    buffer_load_dwordx4 v[188:191], v9, s[16:19], s35 offen
    buffer_load_dwordx4 v[192:195], v10, s[16:19], s35 offen
    s_waitcnt lgkmcnt(0)
    s_barrier
    s_mov_b32 s42, 0
    s_mov_b32 s43, 32768
    s_and_b32 s38, s30, 1
    s_mul_i32 s38, s38, 96
    s_add_u32 s38, s38, s29
    s_cmp_ge_u32 s38, 1024
    s_cbranch_scc1 k1_qkv_kernel_v
    s_cmp_eq_u32 s38, 960
    s_cbranch_scc1 k1_qkv_kernel_mx
    v_mov_b32 v128, 0
    v_mov_b32 v129, 0
    v_mov_b32 v130, 0
    v_mov_b32 v131, 0
    v_mov_b32 v132, 0
    v_mov_b32 v133, 0
    v_mov_b32 v134, 0
    v_mov_b32 v135, 0
    v_mov_b32 v136, 0
    v_mov_b32 v137, 0
    v_mov_b32 v138, 0
    v_mov_b32 v139, 0
    v_mov_b32 v140, 0
    v_mov_b32 v141, 0
    v_mov_b32 v142, 0
    v_mov_b32 v143, 0
    v_mov_b32 v144, 0
    v_mov_b32 v145, 0
    v_mov_b32 v146, 0
    v_mov_b32 v147, 0
    v_mov_b32 v148, 0
    v_mov_b32 v149, 0
    v_mov_b32 v150, 0
    v_mov_b32 v151, 0
    ds_read_b128 v[64:67], v36 offset:0
    ds_read_b64_tr_b16 v[72:73], v40 offset:0
    ds_read_b64_tr_b16 v[74:75], v40 offset:3328
    ds_read_b64_tr_b16 v[76:77], v40 offset:32
    ds_read_b64_tr_b16 v[78:79], v40 offset:3360
    ds_read_b64_tr_b16 v[80:81], v40 offset:64
    ds_read_b64_tr_b16 v[82:83], v40 offset:3392
    ds_read_b64_tr_b16 v[84:85], v40 offset:96
    ds_read_b64_tr_b16 v[86:87], v40 offset:3424
    ds_read_b64_tr_b16 v[88:89], v40 offset:128
    ds_read_b64_tr_b16 v[90:91], v40 offset:3456
    ds_read_b64_tr_b16 v[92:93], v40 offset:160
    ds_read_b64_tr_b16 v[94:95], v40 offset:3488
    s_waitcnt lgkmcnt(10)
    v_mfma_f32_16x16x32_bf16 v[128:131], v[72:75], v[64:67], v[128:131]
    s_waitcnt lgkmcnt(8)
    v_mfma_f32_16x16x32_bf16 v[132:135], v[76:79], v[64:67], v[132:135]
    s_waitcnt lgkmcnt(6)
    v_mfma_f32_16x16x32_bf16 v[136:139], v[80:83], v[64:67], v[136:139]
    s_waitcnt lgkmcnt(4)
    v_mfma_f32_16x16x32_bf16 v[140:143], v[84:87], v[64:67], v[140:143]
    s_waitcnt lgkmcnt(2)
    v_mfma_f32_16x16x32_bf16 v[144:147], v[88:91], v[64:67], v[144:147]
    s_waitcnt lgkmcnt(0)
    v_mfma_f32_16x16x32_bf16 v[148:151], v[92:95], v[64:67], v[148:151]
    ds_read_b128 v[64:67], v37 offset:0
    ds_read_b64_tr_b16 v[72:73], v40 offset:13312
    ds_read_b64_tr_b16 v[74:75], v40 offset:16640
    ds_read_b64_tr_b16 v[76:77], v40 offset:13344
    ds_read_b64_tr_b16 v[78:79], v40 offset:16672
    ds_read_b64_tr_b16 v[80:81], v40 offset:13376
    ds_read_b64_tr_b16 v[82:83], v40 offset:16704
    ds_read_b64_tr_b16 v[84:85], v40 offset:13408
    ds_read_b64_tr_b16 v[86:87], v40 offset:16736
    ds_read_b64_tr_b16 v[88:89], v40 offset:13440
    ds_read_b64_tr_b16 v[90:91], v40 offset:16768
    ds_read_b64_tr_b16 v[92:93], v40 offset:13472
    ds_read_b64_tr_b16 v[94:95], v40 offset:16800
    s_waitcnt lgkmcnt(10)
    v_mfma_f32_16x16x32_bf16 v[128:131], v[72:75], v[64:67], v[128:131]
    s_waitcnt lgkmcnt(8)
    v_mfma_f32_16x16x32_bf16 v[132:135], v[76:79], v[64:67], v[132:135]
    s_waitcnt lgkmcnt(6)
    v_mfma_f32_16x16x32_bf16 v[136:139], v[80:83], v[64:67], v[136:139]
    s_waitcnt lgkmcnt(4)
    v_mfma_f32_16x16x32_bf16 v[140:143], v[84:87], v[64:67], v[140:143]
    s_waitcnt lgkmcnt(2)
    v_mfma_f32_16x16x32_bf16 v[144:147], v[88:91], v[64:67], v[144:147]
    s_waitcnt lgkmcnt(0)
    v_mfma_f32_16x16x32_bf16 v[148:151], v[92:95], v[64:67], v[148:151]
    s_waitcnt vmcnt(6)
    ds_write_b128 v16, v[212:215] offset:26624
    ds_write_b128 v17, v[216:219] offset:26624
    ds_write_b128 v18, v[220:223] offset:26624
    s_mov_b32 s35, 786432
    buffer_load_dwordx4 v[212:215], v8, s[16:19], s35 offen
    buffer_load_dwordx4 v[216:219], v9, s[16:19], s35 offen
    buffer_load_dwordx4 v[220:223], v10, s[16:19], s35 offen
    s_waitcnt lgkmcnt(0)
    s_barrier
    ds_read_b128 v[64:67], v38 offset:0
    ds_read_b64_tr_b16 v[72:73], v40 offset:26624
    ds_read_b64_tr_b16 v[74:75], v40 offset:29952
    ds_read_b64_tr_b16 v[76:77], v40 offset:26656
    ds_read_b64_tr_b16 v[78:79], v40 offset:29984
    ds_read_b64_tr_b16 v[80:81], v40 offset:26688
    ds_read_b64_tr_b16 v[82:83], v40 offset:30016
    ds_read_b64_tr_b16 v[84:85], v40 offset:26720
    ds_read_b64_tr_b16 v[86:87], v40 offset:30048
    ds_read_b64_tr_b16 v[88:89], v40 offset:26752
    ds_read_b64_tr_b16 v[90:91], v40 offset:30080
    ds_read_b64_tr_b16 v[92:93], v40 offset:26784
    ds_read_b64_tr_b16 v[94:95], v40 offset:30112
    s_waitcnt lgkmcnt(10)
    v_mfma_f32_16x16x32_bf16 v[128:131], v[72:75], v[64:67], v[128:131]
    s_waitcnt lgkmcnt(8)
    v_mfma_f32_16x16x32_bf16 v[132:135], v[76:79], v[64:67], v[132:135]
    s_waitcnt lgkmcnt(6)
    v_mfma_f32_16x16x32_bf16 v[136:139], v[80:83], v[64:67], v[136:139]
    s_waitcnt lgkmcnt(4)
    v_mfma_f32_16x16x32_bf16 v[140:143], v[84:87], v[64:67], v[140:143]
    s_waitcnt lgkmcnt(2)
    v_mfma_f32_16x16x32_bf16 v[144:147], v[88:91], v[64:67], v[144:147]
    s_waitcnt lgkmcnt(0)
    v_mfma_f32_16x16x32_bf16 v[148:151], v[92:95], v[64:67], v[148:151]
    ds_read_b128 v[64:67], v39 offset:0
    ds_read_b64_tr_b16 v[72:73], v40 offset:39936
    ds_read_b64_tr_b16 v[74:75], v40 offset:43264
    ds_read_b64_tr_b16 v[76:77], v40 offset:39968
    ds_read_b64_tr_b16 v[78:79], v40 offset:43296
    ds_read_b64_tr_b16 v[80:81], v40 offset:40000
    ds_read_b64_tr_b16 v[82:83], v40 offset:43328
    ds_read_b64_tr_b16 v[84:85], v40 offset:40032
    ds_read_b64_tr_b16 v[86:87], v40 offset:43360
    ds_read_b64_tr_b16 v[88:89], v40 offset:40064
    ds_read_b64_tr_b16 v[90:91], v40 offset:43392
    ds_read_b64_tr_b16 v[92:93], v40 offset:40096
    ds_read_b64_tr_b16 v[94:95], v40 offset:43424
    s_waitcnt lgkmcnt(10)
    v_mfma_f32_16x16x32_bf16 v[128:131], v[72:75], v[64:67], v[128:131]
    s_waitcnt lgkmcnt(8)
    v_mfma_f32_16x16x32_bf16 v[132:135], v[76:79], v[64:67], v[132:135]
    s_waitcnt lgkmcnt(6)
    v_mfma_f32_16x16x32_bf16 v[136:139], v[80:83], v[64:67], v[136:139]
    s_waitcnt lgkmcnt(4)
    v_mfma_f32_16x16x32_bf16 v[140:143], v[84:87], v[64:67], v[140:143]
    s_waitcnt lgkmcnt(2)
    v_mfma_f32_16x16x32_bf16 v[144:147], v[88:91], v[64:67], v[144:147]
    s_waitcnt lgkmcnt(0)
    v_mfma_f32_16x16x32_bf16 v[148:151], v[92:95], v[64:67], v[148:151]
    s_waitcnt vmcnt(6)
    ds_write_b128 v16, v[100:103] offset:0
    ds_write_b128 v17, v[104:107] offset:0
    ds_write_b128 v18, v[108:111] offset:0
    s_mov_b32 s35, 983040
    buffer_load_dwordx4 v[100:103], v8, s[16:19], s35 offen
    buffer_load_dwordx4 v[104:107], v9, s[16:19], s35 offen
    buffer_load_dwordx4 v[108:111], v10, s[16:19], s35 offen
    s_waitcnt lgkmcnt(0)
    s_barrier
    ds_read_b128 v[64:67], v36 offset:256
    ds_read_b64_tr_b16 v[72:73], v40 offset:0
    ds_read_b64_tr_b16 v[74:75], v40 offset:3328
    ds_read_b64_tr_b16 v[76:77], v40 offset:32
    ds_read_b64_tr_b16 v[78:79], v40 offset:3360
    ds_read_b64_tr_b16 v[80:81], v40 offset:64
    ds_read_b64_tr_b16 v[82:83], v40 offset:3392
    ds_read_b64_tr_b16 v[84:85], v40 offset:96
    ds_read_b64_tr_b16 v[86:87], v40 offset:3424
    ds_read_b64_tr_b16 v[88:89], v40 offset:128
    ds_read_b64_tr_b16 v[90:91], v40 offset:3456
    ds_read_b64_tr_b16 v[92:93], v40 offset:160
    ds_read_b64_tr_b16 v[94:95], v40 offset:3488
    s_waitcnt lgkmcnt(10)
    v_mfma_f32_16x16x32_bf16 v[128:131], v[72:75], v[64:67], v[128:131]
    s_waitcnt lgkmcnt(8)
    v_mfma_f32_16x16x32_bf16 v[132:135], v[76:79], v[64:67], v[132:135]
    s_waitcnt lgkmcnt(6)
    v_mfma_f32_16x16x32_bf16 v[136:139], v[80:83], v[64:67], v[136:139]
    s_waitcnt lgkmcnt(4)
    v_mfma_f32_16x16x32_bf16 v[140:143], v[84:87], v[64:67], v[140:143]
    s_waitcnt lgkmcnt(2)
    v_mfma_f32_16x16x32_bf16 v[144:147], v[88:91], v[64:67], v[144:147]
    s_waitcnt lgkmcnt(0)
    v_mfma_f32_16x16x32_bf16 v[148:151], v[92:95], v[64:67], v[148:151]
    ds_read_b128 v[64:67], v37 offset:256
    ds_read_b64_tr_b16 v[72:73], v40 offset:13312
    ds_read_b64_tr_b16 v[74:75], v40 offset:16640
    ds_read_b64_tr_b16 v[76:77], v40 offset:13344
    ds_read_b64_tr_b16 v[78:79], v40 offset:16672
    ds_read_b64_tr_b16 v[80:81], v40 offset:13376
    ds_read_b64_tr_b16 v[82:83], v40 offset:16704
    ds_read_b64_tr_b16 v[84:85], v40 offset:13408
    ds_read_b64_tr_b16 v[86:87], v40 offset:16736
    ds_read_b64_tr_b16 v[88:89], v40 offset:13440
    ds_read_b64_tr_b16 v[90:91], v40 offset:16768
    ds_read_b64_tr_b16 v[92:93], v40 offset:13472
    ds_read_b64_tr_b16 v[94:95], v40 offset:16800
    s_waitcnt lgkmcnt(10)
    v_mfma_f32_16x16x32_bf16 v[128:131], v[72:75], v[64:67], v[128:131]
    s_waitcnt lgkmcnt(8)
    v_mfma_f32_16x16x32_bf16 v[132:135], v[76:79], v[64:67], v[132:135]
    s_waitcnt lgkmcnt(6)
    v_mfma_f32_16x16x32_bf16 v[136:139], v[80:83], v[64:67], v[136:139]
    s_waitcnt lgkmcnt(4)
    v_mfma_f32_16x16x32_bf16 v[140:143], v[84:87], v[64:67], v[140:143]
    s_waitcnt lgkmcnt(2)
    v_mfma_f32_16x16x32_bf16 v[144:147], v[88:91], v[64:67], v[144:147]
    s_waitcnt lgkmcnt(0)
    v_mfma_f32_16x16x32_bf16 v[148:151], v[92:95], v[64:67], v[148:151]
    s_waitcnt vmcnt(6)
    ds_write_b128 v16, v[184:187] offset:26624
    ds_write_b128 v17, v[188:191] offset:26624
    ds_write_b128 v18, v[192:195] offset:26624
    s_mov_b32 s35, 1179648
    buffer_load_dwordx4 v[184:187], v8, s[16:19], s35 offen
    buffer_load_dwordx4 v[188:191], v9, s[16:19], s35 offen
    buffer_load_dwordx4 v[192:195], v10, s[16:19], s35 offen
    s_waitcnt lgkmcnt(0)
    s_barrier
    ds_read_b128 v[64:67], v38 offset:256
    ds_read_b64_tr_b16 v[72:73], v40 offset:26624
    ds_read_b64_tr_b16 v[74:75], v40 offset:29952
    ds_read_b64_tr_b16 v[76:77], v40 offset:26656
    ds_read_b64_tr_b16 v[78:79], v40 offset:29984
    ds_read_b64_tr_b16 v[80:81], v40 offset:26688
    ds_read_b64_tr_b16 v[82:83], v40 offset:30016
    ds_read_b64_tr_b16 v[84:85], v40 offset:26720
    ds_read_b64_tr_b16 v[86:87], v40 offset:30048
    ds_read_b64_tr_b16 v[88:89], v40 offset:26752
    ds_read_b64_tr_b16 v[90:91], v40 offset:30080
    ds_read_b64_tr_b16 v[92:93], v40 offset:26784
    ds_read_b64_tr_b16 v[94:95], v40 offset:30112
    s_waitcnt lgkmcnt(10)
    v_mfma_f32_16x16x32_bf16 v[128:131], v[72:75], v[64:67], v[128:131]
    s_waitcnt lgkmcnt(8)
    v_mfma_f32_16x16x32_bf16 v[132:135], v[76:79], v[64:67], v[132:135]
    s_waitcnt lgkmcnt(6)
    v_mfma_f32_16x16x32_bf16 v[136:139], v[80:83], v[64:67], v[136:139]
    s_waitcnt lgkmcnt(4)
    v_mfma_f32_16x16x32_bf16 v[140:143], v[84:87], v[64:67], v[140:143]
    s_waitcnt lgkmcnt(2)
    v_mfma_f32_16x16x32_bf16 v[144:147], v[88:91], v[64:67], v[144:147]
    s_waitcnt lgkmcnt(0)
    v_mfma_f32_16x16x32_bf16 v[148:151], v[92:95], v[64:67], v[148:151]
    ds_read_b128 v[64:67], v39 offset:256
    ds_read_b64_tr_b16 v[72:73], v40 offset:39936
    ds_read_b64_tr_b16 v[74:75], v40 offset:43264
    ds_read_b64_tr_b16 v[76:77], v40 offset:39968
    ds_read_b64_tr_b16 v[78:79], v40 offset:43296
    ds_read_b64_tr_b16 v[80:81], v40 offset:40000
    ds_read_b64_tr_b16 v[82:83], v40 offset:43328
    ds_read_b64_tr_b16 v[84:85], v40 offset:40032
    ds_read_b64_tr_b16 v[86:87], v40 offset:43360
    ds_read_b64_tr_b16 v[88:89], v40 offset:40064
    ds_read_b64_tr_b16 v[90:91], v40 offset:43392
    ds_read_b64_tr_b16 v[92:93], v40 offset:40096
    ds_read_b64_tr_b16 v[94:95], v40 offset:43424
    s_waitcnt lgkmcnt(10)
    v_mfma_f32_16x16x32_bf16 v[128:131], v[72:75], v[64:67], v[128:131]
    s_waitcnt lgkmcnt(8)
    v_mfma_f32_16x16x32_bf16 v[132:135], v[76:79], v[64:67], v[132:135]
    s_waitcnt lgkmcnt(6)
    v_mfma_f32_16x16x32_bf16 v[136:139], v[80:83], v[64:67], v[136:139]
    s_waitcnt lgkmcnt(4)
    v_mfma_f32_16x16x32_bf16 v[140:143], v[84:87], v[64:67], v[140:143]
    s_waitcnt lgkmcnt(2)
    v_mfma_f32_16x16x32_bf16 v[144:147], v[88:91], v[64:67], v[144:147]
    s_waitcnt lgkmcnt(0)
    v_mfma_f32_16x16x32_bf16 v[148:151], v[92:95], v[64:67], v[148:151]
    s_waitcnt vmcnt(6)
    ds_write_b128 v16, v[212:215] offset:0
    ds_write_b128 v17, v[216:219] offset:0
    ds_write_b128 v18, v[220:223] offset:0
    s_mov_b32 s35, 1376256
    buffer_load_dwordx4 v[212:215], v8, s[16:19], s35 offen
    buffer_load_dwordx4 v[216:219], v9, s[16:19], s35 offen
    buffer_load_dwordx4 v[220:223], v10, s[16:19], s35 offen
    s_waitcnt lgkmcnt(0)
    s_barrier
    ds_read_b128 v[64:67], v36 offset:512
    ds_read_b64_tr_b16 v[72:73], v40 offset:0
    ds_read_b64_tr_b16 v[74:75], v40 offset:3328
    ds_read_b64_tr_b16 v[76:77], v40 offset:32
    ds_read_b64_tr_b16 v[78:79], v40 offset:3360
    ds_read_b64_tr_b16 v[80:81], v40 offset:64
    ds_read_b64_tr_b16 v[82:83], v40 offset:3392
    ds_read_b64_tr_b16 v[84:85], v40 offset:96
    ds_read_b64_tr_b16 v[86:87], v40 offset:3424
    ds_read_b64_tr_b16 v[88:89], v40 offset:128
    ds_read_b64_tr_b16 v[90:91], v40 offset:3456
    ds_read_b64_tr_b16 v[92:93], v40 offset:160
    ds_read_b64_tr_b16 v[94:95], v40 offset:3488
    s_waitcnt lgkmcnt(10)
    v_mfma_f32_16x16x32_bf16 v[128:131], v[72:75], v[64:67], v[128:131]
    s_waitcnt lgkmcnt(8)
    v_mfma_f32_16x16x32_bf16 v[132:135], v[76:79], v[64:67], v[132:135]
    s_waitcnt lgkmcnt(6)
    v_mfma_f32_16x16x32_bf16 v[136:139], v[80:83], v[64:67], v[136:139]
    s_waitcnt lgkmcnt(4)
    v_mfma_f32_16x16x32_bf16 v[140:143], v[84:87], v[64:67], v[140:143]
    s_waitcnt lgkmcnt(2)
    v_mfma_f32_16x16x32_bf16 v[144:147], v[88:91], v[64:67], v[144:147]
    s_waitcnt lgkmcnt(0)
    v_mfma_f32_16x16x32_bf16 v[148:151], v[92:95], v[64:67], v[148:151]
    ds_read_b128 v[64:67], v37 offset:512
    ds_read_b64_tr_b16 v[72:73], v40 offset:13312
    ds_read_b64_tr_b16 v[74:75], v40 offset:16640
    ds_read_b64_tr_b16 v[76:77], v40 offset:13344
    ds_read_b64_tr_b16 v[78:79], v40 offset:16672
    ds_read_b64_tr_b16 v[80:81], v40 offset:13376
    ds_read_b64_tr_b16 v[82:83], v40 offset:16704
    ds_read_b64_tr_b16 v[84:85], v40 offset:13408
    ds_read_b64_tr_b16 v[86:87], v40 offset:16736
    ds_read_b64_tr_b16 v[88:89], v40 offset:13440
    ds_read_b64_tr_b16 v[90:91], v40 offset:16768
    ds_read_b64_tr_b16 v[92:93], v40 offset:13472
    ds_read_b64_tr_b16 v[94:95], v40 offset:16800
    s_waitcnt lgkmcnt(10)
    v_mfma_f32_16x16x32_bf16 v[128:131], v[72:75], v[64:67], v[128:131]
    s_waitcnt lgkmcnt(8)
    v_mfma_f32_16x16x32_bf16 v[132:135], v[76:79], v[64:67], v[132:135]
    s_waitcnt lgkmcnt(6)
    v_mfma_f32_16x16x32_bf16 v[136:139], v[80:83], v[64:67], v[136:139]
    s_waitcnt lgkmcnt(4)
    v_mfma_f32_16x16x32_bf16 v[140:143], v[84:87], v[64:67], v[140:143]
    s_waitcnt lgkmcnt(2)
    v_mfma_f32_16x16x32_bf16 v[144:147], v[88:91], v[64:67], v[144:147]
    s_waitcnt lgkmcnt(0)
    v_mfma_f32_16x16x32_bf16 v[148:151], v[92:95], v[64:67], v[148:151]
    s_waitcnt vmcnt(6)
    ds_write_b128 v16, v[100:103] offset:26624
    ds_write_b128 v17, v[104:107] offset:26624
    ds_write_b128 v18, v[108:111] offset:26624
    s_waitcnt lgkmcnt(0)
    s_barrier
    ds_read_b128 v[64:67], v38 offset:512
    ds_read_b64_tr_b16 v[72:73], v40 offset:26624
    ds_read_b64_tr_b16 v[74:75], v40 offset:29952
    ds_read_b64_tr_b16 v[76:77], v40 offset:26656
    ds_read_b64_tr_b16 v[78:79], v40 offset:29984
    ds_read_b64_tr_b16 v[80:81], v40 offset:26688
    ds_read_b64_tr_b16 v[82:83], v40 offset:30016
    ds_read_b64_tr_b16 v[84:85], v40 offset:26720
    ds_read_b64_tr_b16 v[86:87], v40 offset:30048
    ds_read_b64_tr_b16 v[88:89], v40 offset:26752
    ds_read_b64_tr_b16 v[90:91], v40 offset:30080
    ds_read_b64_tr_b16 v[92:93], v40 offset:26784
    ds_read_b64_tr_b16 v[94:95], v40 offset:30112
    s_waitcnt lgkmcnt(10)
    v_mfma_f32_16x16x32_bf16 v[128:131], v[72:75], v[64:67], v[128:131]
    s_waitcnt lgkmcnt(8)
    v_mfma_f32_16x16x32_bf16 v[132:135], v[76:79], v[64:67], v[132:135]
    s_waitcnt lgkmcnt(6)
    v_mfma_f32_16x16x32_bf16 v[136:139], v[80:83], v[64:67], v[136:139]
    s_waitcnt lgkmcnt(4)
    v_mfma_f32_16x16x32_bf16 v[140:143], v[84:87], v[64:67], v[140:143]
    s_waitcnt lgkmcnt(2)
    v_mfma_f32_16x16x32_bf16 v[144:147], v[88:91], v[64:67], v[144:147]
    s_waitcnt lgkmcnt(0)
    v_mfma_f32_16x16x32_bf16 v[148:151], v[92:95], v[64:67], v[148:151]
    ds_read_b128 v[64:67], v39 offset:512
    ds_read_b64_tr_b16 v[72:73], v40 offset:39936
    ds_read_b64_tr_b16 v[74:75], v40 offset:43264
    ds_read_b64_tr_b16 v[76:77], v40 offset:39968
    ds_read_b64_tr_b16 v[78:79], v40 offset:43296
    ds_read_b64_tr_b16 v[80:81], v40 offset:40000
    ds_read_b64_tr_b16 v[82:83], v40 offset:43328
    ds_read_b64_tr_b16 v[84:85], v40 offset:40032
    ds_read_b64_tr_b16 v[86:87], v40 offset:43360
    ds_read_b64_tr_b16 v[88:89], v40 offset:40064
    ds_read_b64_tr_b16 v[90:91], v40 offset:43392
    ds_read_b64_tr_b16 v[92:93], v40 offset:40096
    ds_read_b64_tr_b16 v[94:95], v40 offset:43424
    s_waitcnt lgkmcnt(10)
    v_mfma_f32_16x16x32_bf16 v[128:131], v[72:75], v[64:67], v[128:131]
    s_waitcnt lgkmcnt(8)
    v_mfma_f32_16x16x32_bf16 v[132:135], v[76:79], v[64:67], v[132:135]
    s_waitcnt lgkmcnt(6)
    v_mfma_f32_16x16x32_bf16 v[136:139], v[80:83], v[64:67], v[136:139]
    s_waitcnt lgkmcnt(4)
    v_mfma_f32_16x16x32_bf16 v[140:143], v[84:87], v[64:67], v[140:143]
    s_waitcnt lgkmcnt(2)
    v_mfma_f32_16x16x32_bf16 v[144:147], v[88:91], v[64:67], v[144:147]
    s_waitcnt lgkmcnt(0)
    v_mfma_f32_16x16x32_bf16 v[148:151], v[92:95], v[64:67], v[148:151]
    s_waitcnt vmcnt(3)
    ds_write_b128 v16, v[184:187] offset:0
    ds_write_b128 v17, v[188:191] offset:0
    ds_write_b128 v18, v[192:195] offset:0
    s_waitcnt lgkmcnt(0)
    s_barrier
    ds_read_b128 v[64:67], v36 offset:768
    ds_read_b64_tr_b16 v[72:73], v40 offset:0
    ds_read_b64_tr_b16 v[74:75], v40 offset:3328
    ds_read_b64_tr_b16 v[76:77], v40 offset:32
    ds_read_b64_tr_b16 v[78:79], v40 offset:3360
    ds_read_b64_tr_b16 v[80:81], v40 offset:64
    ds_read_b64_tr_b16 v[82:83], v40 offset:3392
    ds_read_b64_tr_b16 v[84:85], v40 offset:96
    ds_read_b64_tr_b16 v[86:87], v40 offset:3424
    ds_read_b64_tr_b16 v[88:89], v40 offset:128
    ds_read_b64_tr_b16 v[90:91], v40 offset:3456
    ds_read_b64_tr_b16 v[92:93], v40 offset:160
    ds_read_b64_tr_b16 v[94:95], v40 offset:3488
    s_waitcnt lgkmcnt(10)
    v_mfma_f32_16x16x32_bf16 v[128:131], v[72:75], v[64:67], v[128:131]
    s_waitcnt lgkmcnt(8)
    v_mfma_f32_16x16x32_bf16 v[132:135], v[76:79], v[64:67], v[132:135]
    s_waitcnt lgkmcnt(6)
    v_mfma_f32_16x16x32_bf16 v[136:139], v[80:83], v[64:67], v[136:139]
    s_waitcnt lgkmcnt(4)
    v_mfma_f32_16x16x32_bf16 v[140:143], v[84:87], v[64:67], v[140:143]
    s_waitcnt lgkmcnt(2)
    v_mfma_f32_16x16x32_bf16 v[144:147], v[88:91], v[64:67], v[144:147]
    s_waitcnt lgkmcnt(0)
    v_mfma_f32_16x16x32_bf16 v[148:151], v[92:95], v[64:67], v[148:151]
    ds_read_b128 v[64:67], v37 offset:768
    ds_read_b64_tr_b16 v[72:73], v40 offset:13312
    ds_read_b64_tr_b16 v[74:75], v40 offset:16640
    ds_read_b64_tr_b16 v[76:77], v40 offset:13344
    ds_read_b64_tr_b16 v[78:79], v40 offset:16672
    ds_read_b64_tr_b16 v[80:81], v40 offset:13376
    ds_read_b64_tr_b16 v[82:83], v40 offset:16704
    ds_read_b64_tr_b16 v[84:85], v40 offset:13408
    ds_read_b64_tr_b16 v[86:87], v40 offset:16736
    ds_read_b64_tr_b16 v[88:89], v40 offset:13440
    ds_read_b64_tr_b16 v[90:91], v40 offset:16768
    ds_read_b64_tr_b16 v[92:93], v40 offset:13472
    ds_read_b64_tr_b16 v[94:95], v40 offset:16800
    s_waitcnt lgkmcnt(10)
    v_mfma_f32_16x16x32_bf16 v[128:131], v[72:75], v[64:67], v[128:131]
    s_waitcnt lgkmcnt(8)
    v_mfma_f32_16x16x32_bf16 v[132:135], v[76:79], v[64:67], v[132:135]
    s_waitcnt lgkmcnt(6)
    v_mfma_f32_16x16x32_bf16 v[136:139], v[80:83], v[64:67], v[136:139]
    s_waitcnt lgkmcnt(4)
    v_mfma_f32_16x16x32_bf16 v[140:143], v[84:87], v[64:67], v[140:143]
    s_waitcnt lgkmcnt(2)
    v_mfma_f32_16x16x32_bf16 v[144:147], v[88:91], v[64:67], v[144:147]
    s_waitcnt lgkmcnt(0)
    v_mfma_f32_16x16x32_bf16 v[148:151], v[92:95], v[64:67], v[148:151]
    s_waitcnt vmcnt(0)
    ds_write_b128 v16, v[212:215] offset:26624
    ds_write_b128 v17, v[216:219] offset:26624
    ds_write_b128 v18, v[220:223] offset:26624
    s_waitcnt lgkmcnt(0)
    s_barrier
    ds_read_b128 v[64:67], v38 offset:768
    ds_read_b64_tr_b16 v[72:73], v40 offset:26624
    ds_read_b64_tr_b16 v[74:75], v40 offset:29952
    ds_read_b64_tr_b16 v[76:77], v40 offset:26656
    ds_read_b64_tr_b16 v[78:79], v40 offset:29984
    ds_read_b64_tr_b16 v[80:81], v40 offset:26688
    ds_read_b64_tr_b16 v[82:83], v40 offset:30016
    ds_read_b64_tr_b16 v[84:85], v40 offset:26720
    ds_read_b64_tr_b16 v[86:87], v40 offset:30048
    ds_read_b64_tr_b16 v[88:89], v40 offset:26752
    ds_read_b64_tr_b16 v[90:91], v40 offset:30080
    ds_read_b64_tr_b16 v[92:93], v40 offset:26784
    ds_read_b64_tr_b16 v[94:95], v40 offset:30112
    s_waitcnt lgkmcnt(10)
    v_mfma_f32_16x16x32_bf16 v[128:131], v[72:75], v[64:67], v[128:131]
    s_waitcnt lgkmcnt(8)
    v_mfma_f32_16x16x32_bf16 v[132:135], v[76:79], v[64:67], v[132:135]
    s_waitcnt lgkmcnt(6)
    v_mfma_f32_16x16x32_bf16 v[136:139], v[80:83], v[64:67], v[136:139]
    s_waitcnt lgkmcnt(4)
    v_mfma_f32_16x16x32_bf16 v[140:143], v[84:87], v[64:67], v[140:143]
    s_waitcnt lgkmcnt(2)
    v_mfma_f32_16x16x32_bf16 v[144:147], v[88:91], v[64:67], v[144:147]
    s_waitcnt lgkmcnt(0)
    v_mfma_f32_16x16x32_bf16 v[148:151], v[92:95], v[64:67], v[148:151]
    ds_read_b128 v[64:67], v39 offset:768
    ds_read_b64_tr_b16 v[72:73], v40 offset:39936
    ds_read_b64_tr_b16 v[74:75], v40 offset:43264
    ds_read_b64_tr_b16 v[76:77], v40 offset:39968
    ds_read_b64_tr_b16 v[78:79], v40 offset:43296
    ds_read_b64_tr_b16 v[80:81], v40 offset:40000
    ds_read_b64_tr_b16 v[82:83], v40 offset:43328
    ds_read_b64_tr_b16 v[84:85], v40 offset:40032
    ds_read_b64_tr_b16 v[86:87], v40 offset:43360
    ds_read_b64_tr_b16 v[88:89], v40 offset:40064
    ds_read_b64_tr_b16 v[90:91], v40 offset:43392
    ds_read_b64_tr_b16 v[92:93], v40 offset:40096
    ds_read_b64_tr_b16 v[94:95], v40 offset:43424
    s_waitcnt lgkmcnt(10)
    v_mfma_f32_16x16x32_bf16 v[128:131], v[72:75], v[64:67], v[128:131]
    s_waitcnt lgkmcnt(8)
    v_mfma_f32_16x16x32_bf16 v[132:135], v[76:79], v[64:67], v[132:135]
    s_waitcnt lgkmcnt(6)
    v_mfma_f32_16x16x32_bf16 v[136:139], v[80:83], v[64:67], v[136:139]
    s_waitcnt lgkmcnt(4)
    v_mfma_f32_16x16x32_bf16 v[140:143], v[84:87], v[64:67], v[140:143]
    s_waitcnt lgkmcnt(2)
    v_mfma_f32_16x16x32_bf16 v[144:147], v[88:91], v[64:67], v[144:147]
    s_waitcnt lgkmcnt(0)
    v_mfma_f32_16x16x32_bf16 v[148:151], v[92:95], v[64:67], v[148:151]
    s_nop 7
    s_lshr_b32 s37, s30, 1
    s_lshl_b32 s37, s37, 4
    s_add_u32 s37, s37, s28
    s_and_b32 s38, s30, 1
    s_mul_i32 s38, s38, 96
    s_add_u32 s38, s38, s29
    s_lshl_b32 s38, s38, 12
    v_add_u32 v5, s37, v4
    v_lshlrev_b32 v5, 5, v5
    v_lshl_add_u32 v5, v3, 3, v5
    s_lshl_b32 s37, s37, 5
    v_lshlrev_b32 v7, 5, v4
    v_lshl_add_u32 v7, v3, 3, v7
    v_add_u32 v7, s37, v7
    v_cvt_pk_bf16_f32 v128, v128, v129
    v_cvt_pk_bf16_f32 v129, v130, v131
    s_add_u32 s44, s38, 0
    buffer_store_dwordx2 v[128:129], v5, s[20:23], s44 offen offset:0
    v_cvt_pk_bf16_f32 v132, v132, v133
    v_cvt_pk_bf16_f32 v133, v134, v135
    s_add_u32 s44, s38, 65536
    buffer_store_dwordx2 v[132:133], v5, s[20:23], s44 offen offset:0
    v_cvt_pk_bf16_f32 v136, v136, v137
    v_cvt_pk_bf16_f32 v137, v138, v139
    s_add_u32 s44, s38, 131072
    buffer_store_dwordx2 v[136:137], v5, s[20:23], s44 offen offset:0
    v_cvt_pk_bf16_f32 v140, v140, v141
    v_cvt_pk_bf16_f32 v141, v142, v143
    s_add_u32 s44, s38, 196608
    buffer_store_dwordx2 v[140:141], v5, s[20:23], s44 offen offset:0
    v_cvt_pk_bf16_f32 v144, v144, v145
    v_cvt_pk_bf16_f32 v145, v146, v147
    s_add_u32 s44, s38, 262144
    buffer_store_dwordx2 v[144:145], v5, s[20:23], s44 offen offset:0
    v_cvt_pk_bf16_f32 v148, v148, v149
    v_cvt_pk_bf16_f32 v149, v150, v151
    s_add_u32 s44, s38, 327680
    buffer_store_dwordx2 v[148:149], v5, s[20:23], s44 offen offset:0
    s_endpgm
k1_qkv_kernel_v:
    v_mov_b32 v128, 0
    v_mov_b32 v129, 0
    v_mov_b32 v130, 0
    v_mov_b32 v131, 0
    v_mov_b32 v132, 0
    v_mov_b32 v133, 0
    v_mov_b32 v134, 0
    v_mov_b32 v135, 0
    v_mov_b32 v136, 0
    v_mov_b32 v137, 0
    v_mov_b32 v138, 0
    v_mov_b32 v139, 0
    v_mov_b32 v140, 0
    v_mov_b32 v141, 0
    v_mov_b32 v142, 0
    v_mov_b32 v143, 0
    v_mov_b32 v144, 0
    v_mov_b32 v145, 0
    v_mov_b32 v146, 0
    v_mov_b32 v147, 0
    v_mov_b32 v148, 0
    v_mov_b32 v149, 0
    v_mov_b32 v150, 0
    v_mov_b32 v151, 0
    ds_read_b128 v[64:67], v36 offset:0
    ds_read_b64_tr_b16 v[72:73], v40 offset:0
    ds_read_b64_tr_b16 v[74:75], v40 offset:3328
    ds_read_b64_tr_b16 v[76:77], v40 offset:32
    ds_read_b64_tr_b16 v[78:79], v40 offset:3360
    ds_read_b64_tr_b16 v[80:81], v40 offset:64
    ds_read_b64_tr_b16 v[82:83], v40 offset:3392
    ds_read_b64_tr_b16 v[84:85], v40 offset:96
    ds_read_b64_tr_b16 v[86:87], v40 offset:3424
    ds_read_b64_tr_b16 v[88:89], v40 offset:128
    ds_read_b64_tr_b16 v[90:91], v40 offset:3456
    ds_read_b64_tr_b16 v[92:93], v40 offset:160
    ds_read_b64_tr_b16 v[94:95], v40 offset:3488
    s_waitcnt lgkmcnt(10)
    v_mfma_f32_16x16x32_bf16 v[128:131], v[64:67], v[72:75], v[128:131]
    s_waitcnt lgkmcnt(8)
    v_mfma_f32_16x16x32_bf16 v[132:135], v[64:67], v[76:79], v[132:135]
    s_waitcnt lgkmcnt(6)
    v_mfma_f32_16x16x32_bf16 v[136:139], v[64:67], v[80:83], v[136:139]
    s_waitcnt lgkmcnt(4)
    v_mfma_f32_16x16x32_bf16 v[140:143], v[64:67], v[84:87], v[140:143]
    s_waitcnt lgkmcnt(2)
    v_mfma_f32_16x16x32_bf16 v[144:147], v[64:67], v[88:91], v[144:147]
    s_waitcnt lgkmcnt(0)
    v_mfma_f32_16x16x32_bf16 v[148:151], v[64:67], v[92:95], v[148:151]
    ds_read_b128 v[64:67], v37 offset:0
    ds_read_b64_tr_b16 v[72:73], v40 offset:13312
    ds_read_b64_tr_b16 v[74:75], v40 offset:16640
    ds_read_b64_tr_b16 v[76:77], v40 offset:13344
    ds_read_b64_tr_b16 v[78:79], v40 offset:16672
    ds_read_b64_tr_b16 v[80:81], v40 offset:13376
    ds_read_b64_tr_b16 v[82:83], v40 offset:16704
    ds_read_b64_tr_b16 v[84:85], v40 offset:13408
    ds_read_b64_tr_b16 v[86:87], v40 offset:16736
    ds_read_b64_tr_b16 v[88:89], v40 offset:13440
    ds_read_b64_tr_b16 v[90:91], v40 offset:16768
    ds_read_b64_tr_b16 v[92:93], v40 offset:13472
    ds_read_b64_tr_b16 v[94:95], v40 offset:16800
    s_waitcnt lgkmcnt(10)
    v_mfma_f32_16x16x32_bf16 v[128:131], v[64:67], v[72:75], v[128:131]
    s_waitcnt lgkmcnt(8)
    v_mfma_f32_16x16x32_bf16 v[132:135], v[64:67], v[76:79], v[132:135]
    s_waitcnt lgkmcnt(6)
    v_mfma_f32_16x16x32_bf16 v[136:139], v[64:67], v[80:83], v[136:139]
    s_waitcnt lgkmcnt(4)
    v_mfma_f32_16x16x32_bf16 v[140:143], v[64:67], v[84:87], v[140:143]
    s_waitcnt lgkmcnt(2)
    v_mfma_f32_16x16x32_bf16 v[144:147], v[64:67], v[88:91], v[144:147]
    s_waitcnt lgkmcnt(0)
    v_mfma_f32_16x16x32_bf16 v[148:151], v[64:67], v[92:95], v[148:151]
    s_waitcnt vmcnt(6)
    ds_write_b128 v16, v[212:215] offset:26624
    ds_write_b128 v17, v[216:219] offset:26624
    ds_write_b128 v18, v[220:223] offset:26624
    s_mov_b32 s35, 786432
    buffer_load_dwordx4 v[212:215], v8, s[16:19], s35 offen
    buffer_load_dwordx4 v[216:219], v9, s[16:19], s35 offen
    buffer_load_dwordx4 v[220:223], v10, s[16:19], s35 offen
    s_waitcnt lgkmcnt(0)
    s_barrier
    ds_read_b128 v[64:67], v38 offset:0
    ds_read_b64_tr_b16 v[72:73], v40 offset:26624
    ds_read_b64_tr_b16 v[74:75], v40 offset:29952
    ds_read_b64_tr_b16 v[76:77], v40 offset:26656
    ds_read_b64_tr_b16 v[78:79], v40 offset:29984
    ds_read_b64_tr_b16 v[80:81], v40 offset:26688
    ds_read_b64_tr_b16 v[82:83], v40 offset:30016
    ds_read_b64_tr_b16 v[84:85], v40 offset:26720
    ds_read_b64_tr_b16 v[86:87], v40 offset:30048
    ds_read_b64_tr_b16 v[88:89], v40 offset:26752
    ds_read_b64_tr_b16 v[90:91], v40 offset:30080
    ds_read_b64_tr_b16 v[92:93], v40 offset:26784
    ds_read_b64_tr_b16 v[94:95], v40 offset:30112
    s_waitcnt lgkmcnt(10)
    v_mfma_f32_16x16x32_bf16 v[128:131], v[64:67], v[72:75], v[128:131]
    s_waitcnt lgkmcnt(8)
    v_mfma_f32_16x16x32_bf16 v[132:135], v[64:67], v[76:79], v[132:135]
    s_waitcnt lgkmcnt(6)
    v_mfma_f32_16x16x32_bf16 v[136:139], v[64:67], v[80:83], v[136:139]
    s_waitcnt lgkmcnt(4)
    v_mfma_f32_16x16x32_bf16 v[140:143], v[64:67], v[84:87], v[140:143]
    s_waitcnt lgkmcnt(2)
    v_mfma_f32_16x16x32_bf16 v[144:147], v[64:67], v[88:91], v[144:147]
    s_waitcnt lgkmcnt(0)
    v_mfma_f32_16x16x32_bf16 v[148:151], v[64:67], v[92:95], v[148:151]
    ds_read_b128 v[64:67], v39 offset:0
    ds_read_b64_tr_b16 v[72:73], v40 offset:39936
    ds_read_b64_tr_b16 v[74:75], v40 offset:43264
    ds_read_b64_tr_b16 v[76:77], v40 offset:39968
    ds_read_b64_tr_b16 v[78:79], v40 offset:43296
    ds_read_b64_tr_b16 v[80:81], v40 offset:40000
    ds_read_b64_tr_b16 v[82:83], v40 offset:43328
    ds_read_b64_tr_b16 v[84:85], v40 offset:40032
    ds_read_b64_tr_b16 v[86:87], v40 offset:43360
    ds_read_b64_tr_b16 v[88:89], v40 offset:40064
    ds_read_b64_tr_b16 v[90:91], v40 offset:43392
    ds_read_b64_tr_b16 v[92:93], v40 offset:40096
    ds_read_b64_tr_b16 v[94:95], v40 offset:43424
    s_waitcnt lgkmcnt(10)
    v_mfma_f32_16x16x32_bf16 v[128:131], v[64:67], v[72:75], v[128:131]
    s_waitcnt lgkmcnt(8)
    v_mfma_f32_16x16x32_bf16 v[132:135], v[64:67], v[76:79], v[132:135]
    s_waitcnt lgkmcnt(6)
    v_mfma_f32_16x16x32_bf16 v[136:139], v[64:67], v[80:83], v[136:139]
    s_waitcnt lgkmcnt(4)
    v_mfma_f32_16x16x32_bf16 v[140:143], v[64:67], v[84:87], v[140:143]
    s_waitcnt lgkmcnt(2)
    v_mfma_f32_16x16x32_bf16 v[144:147], v[64:67], v[88:91], v[144:147]
    s_waitcnt lgkmcnt(0)
    v_mfma_f32_16x16x32_bf16 v[148:151], v[64:67], v[92:95], v[148:151]
    s_waitcnt vmcnt(6)
    ds_write_b128 v16, v[100:103] offset:0
    ds_write_b128 v17, v[104:107] offset:0
    ds_write_b128 v18, v[108:111] offset:0
    s_mov_b32 s35, 983040
    buffer_load_dwordx4 v[100:103], v8, s[16:19], s35 offen
    buffer_load_dwordx4 v[104:107], v9, s[16:19], s35 offen
    buffer_load_dwordx4 v[108:111], v10, s[16:19], s35 offen
    s_waitcnt lgkmcnt(0)
    s_barrier
    ds_read_b128 v[64:67], v36 offset:256
    ds_read_b64_tr_b16 v[72:73], v40 offset:0
    ds_read_b64_tr_b16 v[74:75], v40 offset:3328
    ds_read_b64_tr_b16 v[76:77], v40 offset:32
    ds_read_b64_tr_b16 v[78:79], v40 offset:3360
    ds_read_b64_tr_b16 v[80:81], v40 offset:64
    ds_read_b64_tr_b16 v[82:83], v40 offset:3392
    ds_read_b64_tr_b16 v[84:85], v40 offset:96
    ds_read_b64_tr_b16 v[86:87], v40 offset:3424
    ds_read_b64_tr_b16 v[88:89], v40 offset:128
    ds_read_b64_tr_b16 v[90:91], v40 offset:3456
    ds_read_b64_tr_b16 v[92:93], v40 offset:160
    ds_read_b64_tr_b16 v[94:95], v40 offset:3488
    s_waitcnt lgkmcnt(10)
    v_mfma_f32_16x16x32_bf16 v[128:131], v[64:67], v[72:75], v[128:131]
    s_waitcnt lgkmcnt(8)
    v_mfma_f32_16x16x32_bf16 v[132:135], v[64:67], v[76:79], v[132:135]
    s_waitcnt lgkmcnt(6)
    v_mfma_f32_16x16x32_bf16 v[136:139], v[64:67], v[80:83], v[136:139]
    s_waitcnt lgkmcnt(4)
    v_mfma_f32_16x16x32_bf16 v[140:143], v[64:67], v[84:87], v[140:143]
    s_waitcnt lgkmcnt(2)
    v_mfma_f32_16x16x32_bf16 v[144:147], v[64:67], v[88:91], v[144:147]
    s_waitcnt lgkmcnt(0)
    v_mfma_f32_16x16x32_bf16 v[148:151], v[64:67], v[92:95], v[148:151]
    ds_read_b128 v[64:67], v37 offset:256
    ds_read_b64_tr_b16 v[72:73], v40 offset:13312
    ds_read_b64_tr_b16 v[74:75], v40 offset:16640
    ds_read_b64_tr_b16 v[76:77], v40 offset:13344
    ds_read_b64_tr_b16 v[78:79], v40 offset:16672
    ds_read_b64_tr_b16 v[80:81], v40 offset:13376
    ds_read_b64_tr_b16 v[82:83], v40 offset:16704
    ds_read_b64_tr_b16 v[84:85], v40 offset:13408
    ds_read_b64_tr_b16 v[86:87], v40 offset:16736
    ds_read_b64_tr_b16 v[88:89], v40 offset:13440
    ds_read_b64_tr_b16 v[90:91], v40 offset:16768
    ds_read_b64_tr_b16 v[92:93], v40 offset:13472
    ds_read_b64_tr_b16 v[94:95], v40 offset:16800
    s_waitcnt lgkmcnt(10)
    v_mfma_f32_16x16x32_bf16 v[128:131], v[64:67], v[72:75], v[128:131]
    s_waitcnt lgkmcnt(8)
    v_mfma_f32_16x16x32_bf16 v[132:135], v[64:67], v[76:79], v[132:135]
    s_waitcnt lgkmcnt(6)
    v_mfma_f32_16x16x32_bf16 v[136:139], v[64:67], v[80:83], v[136:139]
    s_waitcnt lgkmcnt(4)
    v_mfma_f32_16x16x32_bf16 v[140:143], v[64:67], v[84:87], v[140:143]
    s_waitcnt lgkmcnt(2)
    v_mfma_f32_16x16x32_bf16 v[144:147], v[64:67], v[88:91], v[144:147]
    s_waitcnt lgkmcnt(0)
    v_mfma_f32_16x16x32_bf16 v[148:151], v[64:67], v[92:95], v[148:151]
    s_waitcnt vmcnt(6)
    ds_write_b128 v16, v[184:187] offset:26624
    ds_write_b128 v17, v[188:191] offset:26624
    ds_write_b128 v18, v[192:195] offset:26624
    s_mov_b32 s35, 1179648
    buffer_load_dwordx4 v[184:187], v8, s[16:19], s35 offen
    buffer_load_dwordx4 v[188:191], v9, s[16:19], s35 offen
    buffer_load_dwordx4 v[192:195], v10, s[16:19], s35 offen
    s_waitcnt lgkmcnt(0)
    s_barrier
    ds_read_b128 v[64:67], v38 offset:256
    ds_read_b64_tr_b16 v[72:73], v40 offset:26624
    ds_read_b64_tr_b16 v[74:75], v40 offset:29952
    ds_read_b64_tr_b16 v[76:77], v40 offset:26656
    ds_read_b64_tr_b16 v[78:79], v40 offset:29984
    ds_read_b64_tr_b16 v[80:81], v40 offset:26688
    ds_read_b64_tr_b16 v[82:83], v40 offset:30016
    ds_read_b64_tr_b16 v[84:85], v40 offset:26720
    ds_read_b64_tr_b16 v[86:87], v40 offset:30048
    ds_read_b64_tr_b16 v[88:89], v40 offset:26752
    ds_read_b64_tr_b16 v[90:91], v40 offset:30080
    ds_read_b64_tr_b16 v[92:93], v40 offset:26784
    ds_read_b64_tr_b16 v[94:95], v40 offset:30112
    s_waitcnt lgkmcnt(10)
    v_mfma_f32_16x16x32_bf16 v[128:131], v[64:67], v[72:75], v[128:131]
    s_waitcnt lgkmcnt(8)
    v_mfma_f32_16x16x32_bf16 v[132:135], v[64:67], v[76:79], v[132:135]
    s_waitcnt lgkmcnt(6)
    v_mfma_f32_16x16x32_bf16 v[136:139], v[64:67], v[80:83], v[136:139]
    s_waitcnt lgkmcnt(4)
    v_mfma_f32_16x16x32_bf16 v[140:143], v[64:67], v[84:87], v[140:143]
    s_waitcnt lgkmcnt(2)
    v_mfma_f32_16x16x32_bf16 v[144:147], v[64:67], v[88:91], v[144:147]
    s_waitcnt lgkmcnt(0)
    v_mfma_f32_16x16x32_bf16 v[148:151], v[64:67], v[92:95], v[148:151]
    ds_read_b128 v[64:67], v39 offset:256
    ds_read_b64_tr_b16 v[72:73], v40 offset:39936
    ds_read_b64_tr_b16 v[74:75], v40 offset:43264
    ds_read_b64_tr_b16 v[76:77], v40 offset:39968
    ds_read_b64_tr_b16 v[78:79], v40 offset:43296
    ds_read_b64_tr_b16 v[80:81], v40 offset:40000
    ds_read_b64_tr_b16 v[82:83], v40 offset:43328
    ds_read_b64_tr_b16 v[84:85], v40 offset:40032
    ds_read_b64_tr_b16 v[86:87], v40 offset:43360
    ds_read_b64_tr_b16 v[88:89], v40 offset:40064
    ds_read_b64_tr_b16 v[90:91], v40 offset:43392
    ds_read_b64_tr_b16 v[92:93], v40 offset:40096
    ds_read_b64_tr_b16 v[94:95], v40 offset:43424
    s_waitcnt lgkmcnt(10)
    v_mfma_f32_16x16x32_bf16 v[128:131], v[64:67], v[72:75], v[128:131]
    s_waitcnt lgkmcnt(8)
    v_mfma_f32_16x16x32_bf16 v[132:135], v[64:67], v[76:79], v[132:135]
    s_waitcnt lgkmcnt(6)
    v_mfma_f32_16x16x32_bf16 v[136:139], v[64:67], v[80:83], v[136:139]
    s_waitcnt lgkmcnt(4)
    v_mfma_f32_16x16x32_bf16 v[140:143], v[64:67], v[84:87], v[140:143]
    s_waitcnt lgkmcnt(2)
    v_mfma_f32_16x16x32_bf16 v[144:147], v[64:67], v[88:91], v[144:147]
    s_waitcnt lgkmcnt(0)
    v_mfma_f32_16x16x32_bf16 v[148:151], v[64:67], v[92:95], v[148:151]
    s_waitcnt vmcnt(6)
    ds_write_b128 v16, v[212:215] offset:0
    ds_write_b128 v17, v[216:219] offset:0
    ds_write_b128 v18, v[220:223] offset:0
    s_mov_b32 s35, 1376256
    buffer_load_dwordx4 v[212:215], v8, s[16:19], s35 offen
    buffer_load_dwordx4 v[216:219], v9, s[16:19], s35 offen
    buffer_load_dwordx4 v[220:223], v10, s[16:19], s35 offen
    s_waitcnt lgkmcnt(0)
    s_barrier
    ds_read_b128 v[64:67], v36 offset:512
    ds_read_b64_tr_b16 v[72:73], v40 offset:0
    ds_read_b64_tr_b16 v[74:75], v40 offset:3328
    ds_read_b64_tr_b16 v[76:77], v40 offset:32
    ds_read_b64_tr_b16 v[78:79], v40 offset:3360
    ds_read_b64_tr_b16 v[80:81], v40 offset:64
    ds_read_b64_tr_b16 v[82:83], v40 offset:3392
    ds_read_b64_tr_b16 v[84:85], v40 offset:96
    ds_read_b64_tr_b16 v[86:87], v40 offset:3424
    ds_read_b64_tr_b16 v[88:89], v40 offset:128
    ds_read_b64_tr_b16 v[90:91], v40 offset:3456
    ds_read_b64_tr_b16 v[92:93], v40 offset:160
    ds_read_b64_tr_b16 v[94:95], v40 offset:3488
    s_waitcnt lgkmcnt(10)
    v_mfma_f32_16x16x32_bf16 v[128:131], v[64:67], v[72:75], v[128:131]
    s_waitcnt lgkmcnt(8)
    v_mfma_f32_16x16x32_bf16 v[132:135], v[64:67], v[76:79], v[132:135]
    s_waitcnt lgkmcnt(6)
    v_mfma_f32_16x16x32_bf16 v[136:139], v[64:67], v[80:83], v[136:139]
    s_waitcnt lgkmcnt(4)
    v_mfma_f32_16x16x32_bf16 v[140:143], v[64:67], v[84:87], v[140:143]
    s_waitcnt lgkmcnt(2)
    v_mfma_f32_16x16x32_bf16 v[144:147], v[64:67], v[88:91], v[144:147]
    s_waitcnt lgkmcnt(0)
    v_mfma_f32_16x16x32_bf16 v[148:151], v[64:67], v[92:95], v[148:151]
    ds_read_b128 v[64:67], v37 offset:512
    ds_read_b64_tr_b16 v[72:73], v40 offset:13312
    ds_read_b64_tr_b16 v[74:75], v40 offset:16640
    ds_read_b64_tr_b16 v[76:77], v40 offset:13344
    ds_read_b64_tr_b16 v[78:79], v40 offset:16672
    ds_read_b64_tr_b16 v[80:81], v40 offset:13376
    ds_read_b64_tr_b16 v[82:83], v40 offset:16704
    ds_read_b64_tr_b16 v[84:85], v40 offset:13408
    ds_read_b64_tr_b16 v[86:87], v40 offset:16736
    ds_read_b64_tr_b16 v[88:89], v40 offset:13440
    ds_read_b64_tr_b16 v[90:91], v40 offset:16768
    ds_read_b64_tr_b16 v[92:93], v40 offset:13472
    ds_read_b64_tr_b16 v[94:95], v40 offset:16800
    s_waitcnt lgkmcnt(10)
    v_mfma_f32_16x16x32_bf16 v[128:131], v[64:67], v[72:75], v[128:131]
    s_waitcnt lgkmcnt(8)
    v_mfma_f32_16x16x32_bf16 v[132:135], v[64:67], v[76:79], v[132:135]
    s_waitcnt lgkmcnt(6)
    v_mfma_f32_16x16x32_bf16 v[136:139], v[64:67], v[80:83], v[136:139]
    s_waitcnt lgkmcnt(4)
    v_mfma_f32_16x16x32_bf16 v[140:143], v[64:67], v[84:87], v[140:143]
    s_waitcnt lgkmcnt(2)
    v_mfma_f32_16x16x32_bf16 v[144:147], v[64:67], v[88:91], v[144:147]
    s_waitcnt lgkmcnt(0)
    v_mfma_f32_16x16x32_bf16 v[148:151], v[64:67], v[92:95], v[148:151]
    s_waitcnt vmcnt(6)
    ds_write_b128 v16, v[100:103] offset:26624
    ds_write_b128 v17, v[104:107] offset:26624
    ds_write_b128 v18, v[108:111] offset:26624
    s_waitcnt lgkmcnt(0)
    s_barrier
    ds_read_b128 v[64:67], v38 offset:512
    ds_read_b64_tr_b16 v[72:73], v40 offset:26624
    ds_read_b64_tr_b16 v[74:75], v40 offset:29952
    ds_read_b64_tr_b16 v[76:77], v40 offset:26656
    ds_read_b64_tr_b16 v[78:79], v40 offset:29984
    ds_read_b64_tr_b16 v[80:81], v40 offset:26688
    ds_read_b64_tr_b16 v[82:83], v40 offset:30016
    ds_read_b64_tr_b16 v[84:85], v40 offset:26720
    ds_read_b64_tr_b16 v[86:87], v40 offset:30048
    ds_read_b64_tr_b16 v[88:89], v40 offset:26752
    ds_read_b64_tr_b16 v[90:91], v40 offset:30080
    ds_read_b64_tr_b16 v[92:93], v40 offset:26784
    ds_read_b64_tr_b16 v[94:95], v40 offset:30112
    s_waitcnt lgkmcnt(10)
    v_mfma_f32_16x16x32_bf16 v[128:131], v[64:67], v[72:75], v[128:131]
    s_waitcnt lgkmcnt(8)
    v_mfma_f32_16x16x32_bf16 v[132:135], v[64:67], v[76:79], v[132:135]
    s_waitcnt lgkmcnt(6)
    v_mfma_f32_16x16x32_bf16 v[136:139], v[64:67], v[80:83], v[136:139]
    s_waitcnt lgkmcnt(4)
    v_mfma_f32_16x16x32_bf16 v[140:143], v[64:67], v[84:87], v[140:143]
    s_waitcnt lgkmcnt(2)
    v_mfma_f32_16x16x32_bf16 v[144:147], v[64:67], v[88:91], v[144:147]
    s_waitcnt lgkmcnt(0)
    v_mfma_f32_16x16x32_bf16 v[148:151], v[64:67], v[92:95], v[148:151]
    ds_read_b128 v[64:67], v39 offset:512
    ds_read_b64_tr_b16 v[72:73], v40 offset:39936
    ds_read_b64_tr_b16 v[74:75], v40 offset:43264
    ds_read_b64_tr_b16 v[76:77], v40 offset:39968
    ds_read_b64_tr_b16 v[78:79], v40 offset:43296
    ds_read_b64_tr_b16 v[80:81], v40 offset:40000
    ds_read_b64_tr_b16 v[82:83], v40 offset:43328
    ds_read_b64_tr_b16 v[84:85], v40 offset:40032
    ds_read_b64_tr_b16 v[86:87], v40 offset:43360
    ds_read_b64_tr_b16 v[88:89], v40 offset:40064
    ds_read_b64_tr_b16 v[90:91], v40 offset:43392
    ds_read_b64_tr_b16 v[92:93], v40 offset:40096
    ds_read_b64_tr_b16 v[94:95], v40 offset:43424
    s_waitcnt lgkmcnt(10)
    v_mfma_f32_16x16x32_bf16 v[128:131], v[64:67], v[72:75], v[128:131]
    s_waitcnt lgkmcnt(8)
    v_mfma_f32_16x16x32_bf16 v[132:135], v[64:67], v[76:79], v[132:135]
    s_waitcnt lgkmcnt(6)
    v_mfma_f32_16x16x32_bf16 v[136:139], v[64:67], v[80:83], v[136:139]
    s_waitcnt lgkmcnt(4)
    v_mfma_f32_16x16x32_bf16 v[140:143], v[64:67], v[84:87], v[140:143]
    s_waitcnt lgkmcnt(2)
    v_mfma_f32_16x16x32_bf16 v[144:147], v[64:67], v[88:91], v[144:147]
    s_waitcnt lgkmcnt(0)
    v_mfma_f32_16x16x32_bf16 v[148:151], v[64:67], v[92:95], v[148:151]
    s_waitcnt vmcnt(3)
    ds_write_b128 v16, v[184:187] offset:0
    ds_write_b128 v17, v[188:191] offset:0
    ds_write_b128 v18, v[192:195] offset:0
    s_waitcnt lgkmcnt(0)
    s_barrier
    ds_read_b128 v[64:67], v36 offset:768
    ds_read_b64_tr_b16 v[72:73], v40 offset:0
    ds_read_b64_tr_b16 v[74:75], v40 offset:3328
    ds_read_b64_tr_b16 v[76:77], v40 offset:32
    ds_read_b64_tr_b16 v[78:79], v40 offset:3360
    ds_read_b64_tr_b16 v[80:81], v40 offset:64
    ds_read_b64_tr_b16 v[82:83], v40 offset:3392
    ds_read_b64_tr_b16 v[84:85], v40 offset:96
    ds_read_b64_tr_b16 v[86:87], v40 offset:3424
    ds_read_b64_tr_b16 v[88:89], v40 offset:128
    ds_read_b64_tr_b16 v[90:91], v40 offset:3456
    ds_read_b64_tr_b16 v[92:93], v40 offset:160
    ds_read_b64_tr_b16 v[94:95], v40 offset:3488
    s_waitcnt lgkmcnt(10)
    v_mfma_f32_16x16x32_bf16 v[128:131], v[64:67], v[72:75], v[128:131]
    s_waitcnt lgkmcnt(8)
    v_mfma_f32_16x16x32_bf16 v[132:135], v[64:67], v[76:79], v[132:135]
    s_waitcnt lgkmcnt(6)
    v_mfma_f32_16x16x32_bf16 v[136:139], v[64:67], v[80:83], v[136:139]
    s_waitcnt lgkmcnt(4)
    v_mfma_f32_16x16x32_bf16 v[140:143], v[64:67], v[84:87], v[140:143]
    s_waitcnt lgkmcnt(2)
    v_mfma_f32_16x16x32_bf16 v[144:147], v[64:67], v[88:91], v[144:147]
    s_waitcnt lgkmcnt(0)
    v_mfma_f32_16x16x32_bf16 v[148:151], v[64:67], v[92:95], v[148:151]
    ds_read_b128 v[64:67], v37 offset:768
    ds_read_b64_tr_b16 v[72:73], v40 offset:13312
    ds_read_b64_tr_b16 v[74:75], v40 offset:16640
    ds_read_b64_tr_b16 v[76:77], v40 offset:13344
    ds_read_b64_tr_b16 v[78:79], v40 offset:16672
    ds_read_b64_tr_b16 v[80:81], v40 offset:13376
    ds_read_b64_tr_b16 v[82:83], v40 offset:16704
    ds_read_b64_tr_b16 v[84:85], v40 offset:13408
    ds_read_b64_tr_b16 v[86:87], v40 offset:16736
    ds_read_b64_tr_b16 v[88:89], v40 offset:13440
    ds_read_b64_tr_b16 v[90:91], v40 offset:16768
    ds_read_b64_tr_b16 v[92:93], v40 offset:13472
    ds_read_b64_tr_b16 v[94:95], v40 offset:16800
    s_waitcnt lgkmcnt(10)
    v_mfma_f32_16x16x32_bf16 v[128:131], v[64:67], v[72:75], v[128:131]
    s_waitcnt lgkmcnt(8)
    v_mfma_f32_16x16x32_bf16 v[132:135], v[64:67], v[76:79], v[132:135]
    s_waitcnt lgkmcnt(6)
    v_mfma_f32_16x16x32_bf16 v[136:139], v[64:67], v[80:83], v[136:139]
    s_waitcnt lgkmcnt(4)
    v_mfma_f32_16x16x32_bf16 v[140:143], v[64:67], v[84:87], v[140:143]
    s_waitcnt lgkmcnt(2)
    v_mfma_f32_16x16x32_bf16 v[144:147], v[64:67], v[88:91], v[144:147]
    s_waitcnt lgkmcnt(0)
    v_mfma_f32_16x16x32_bf16 v[148:151], v[64:67], v[92:95], v[148:151]
    s_waitcnt vmcnt(0)
    ds_write_b128 v16, v[212:215] offset:26624
    ds_write_b128 v17, v[216:219] offset:26624
    ds_write_b128 v18, v[220:223] offset:26624
    s_waitcnt lgkmcnt(0)
    s_barrier
    ds_read_b128 v[64:67], v38 offset:768
    ds_read_b64_tr_b16 v[72:73], v40 offset:26624
    ds_read_b64_tr_b16 v[74:75], v40 offset:29952
    ds_read_b64_tr_b16 v[76:77], v40 offset:26656
    ds_read_b64_tr_b16 v[78:79], v40 offset:29984
    ds_read_b64_tr_b16 v[80:81], v40 offset:26688
    ds_read_b64_tr_b16 v[82:83], v40 offset:30016
    ds_read_b64_tr_b16 v[84:85], v40 offset:26720
    ds_read_b64_tr_b16 v[86:87], v40 offset:30048
    ds_read_b64_tr_b16 v[88:89], v40 offset:26752
    ds_read_b64_tr_b16 v[90:91], v40 offset:30080
    ds_read_b64_tr_b16 v[92:93], v40 offset:26784
    ds_read_b64_tr_b16 v[94:95], v40 offset:30112
    s_waitcnt lgkmcnt(10)
    v_mfma_f32_16x16x32_bf16 v[128:131], v[64:67], v[72:75], v[128:131]
    s_waitcnt lgkmcnt(8)
    v_mfma_f32_16x16x32_bf16 v[132:135], v[64:67], v[76:79], v[132:135]
    s_waitcnt lgkmcnt(6)
    v_mfma_f32_16x16x32_bf16 v[136:139], v[64:67], v[80:83], v[136:139]
    s_waitcnt lgkmcnt(4)
    v_mfma_f32_16x16x32_bf16 v[140:143], v[64:67], v[84:87], v[140:143]
    s_waitcnt lgkmcnt(2)
    v_mfma_f32_16x16x32_bf16 v[144:147], v[64:67], v[88:91], v[144:147]
    s_waitcnt lgkmcnt(0)
    v_mfma_f32_16x16x32_bf16 v[148:151], v[64:67], v[92:95], v[148:151]
    ds_read_b128 v[64:67], v39 offset:768
    ds_read_b64_tr_b16 v[72:73], v40 offset:39936
    ds_read_b64_tr_b16 v[74:75], v40 offset:43264
    ds_read_b64_tr_b16 v[76:77], v40 offset:39968
    ds_read_b64_tr_b16 v[78:79], v40 offset:43296
    ds_read_b64_tr_b16 v[80:81], v40 offset:40000
    ds_read_b64_tr_b16 v[82:83], v40 offset:43328
    ds_read_b64_tr_b16 v[84:85], v40 offset:40032
    ds_read_b64_tr_b16 v[86:87], v40 offset:43360
    ds_read_b64_tr_b16 v[88:89], v40 offset:40064
    ds_read_b64_tr_b16 v[90:91], v40 offset:43392
    ds_read_b64_tr_b16 v[92:93], v40 offset:40096
    ds_read_b64_tr_b16 v[94:95], v40 offset:43424
    s_waitcnt lgkmcnt(10)
    v_mfma_f32_16x16x32_bf16 v[128:131], v[64:67], v[72:75], v[128:131]
    s_waitcnt lgkmcnt(8)
    v_mfma_f32_16x16x32_bf16 v[132:135], v[64:67], v[76:79], v[132:135]
    s_waitcnt lgkmcnt(6)
    v_mfma_f32_16x16x32_bf16 v[136:139], v[64:67], v[80:83], v[136:139]
    s_waitcnt lgkmcnt(4)
    v_mfma_f32_16x16x32_bf16 v[140:143], v[64:67], v[84:87], v[140:143]
    s_waitcnt lgkmcnt(2)
    v_mfma_f32_16x16x32_bf16 v[144:147], v[64:67], v[88:91], v[144:147]
    s_waitcnt lgkmcnt(0)
    v_mfma_f32_16x16x32_bf16 v[148:151], v[64:67], v[92:95], v[148:151]
    s_nop 7
    s_lshr_b32 s37, s30, 1
    s_lshl_b32 s37, s37, 4
    s_add_u32 s37, s37, s28
    s_and_b32 s38, s30, 1
    s_mul_i32 s38, s38, 96
    s_add_u32 s38, s38, s29
    s_lshl_b32 s38, s38, 12
    v_add_u32 v5, s37, v4
    v_lshlrev_b32 v5, 5, v5
    v_lshl_add_u32 v5, v3, 3, v5
    s_lshl_b32 s37, s37, 5
    v_lshlrev_b32 v7, 5, v4
    v_lshl_add_u32 v7, v3, 3, v7
    v_add_u32 v7, s37, v7
    v_cvt_pk_bf16_f32 v128, v128, v129
    v_cvt_pk_bf16_f32 v129, v130, v131
    s_add_u32 s44, s38, -4194304
    buffer_store_dwordx2 v[128:129], v7, s[24:27], s44 offen offset:0
    v_cvt_pk_bf16_f32 v132, v132, v133
    v_cvt_pk_bf16_f32 v133, v134, v135
    s_add_u32 s44, s38, -4128768
    buffer_store_dwordx2 v[132:133], v7, s[24:27], s44 offen offset:0
    v_cvt_pk_bf16_f32 v136, v136, v137
    v_cvt_pk_bf16_f32 v137, v138, v139
    s_add_u32 s44, s38, -4063232
    buffer_store_dwordx2 v[136:137], v7, s[24:27], s44 offen offset:0
    v_cvt_pk_bf16_f32 v140, v140, v141
    v_cvt_pk_bf16_f32 v141, v142, v143
    s_add_u32 s44, s38, -3997696
    buffer_store_dwordx2 v[140:141], v7, s[24:27], s44 offen offset:0
    v_cvt_pk_bf16_f32 v144, v144, v145
    v_cvt_pk_bf16_f32 v145, v146, v147
    s_add_u32 s44, s38, -3932160
    buffer_store_dwordx2 v[144:145], v7, s[24:27], s44 offen offset:0
    v_cvt_pk_bf16_f32 v148, v148, v149
    v_cvt_pk_bf16_f32 v149, v150, v151
    s_add_u32 s44, s38, -3866624
    buffer_store_dwordx2 v[148:149], v7, s[24:27], s44 offen offset:0
    s_endpgm
k1_qkv_kernel_mx:
    v_mov_b32 v128, 0
    v_mov_b32 v129, 0
    v_mov_b32 v130, 0
    v_mov_b32 v131, 0
    v_mov_b32 v132, 0
    v_mov_b32 v133, 0
    v_mov_b32 v134, 0
    v_mov_b32 v135, 0
    v_mov_b32 v136, 0
    v_mov_b32 v137, 0
    v_mov_b32 v138, 0
    v_mov_b32 v139, 0
    v_mov_b32 v140, 0
    v_mov_b32 v141, 0
    v_mov_b32 v142, 0
    v_mov_b32 v143, 0
    v_mov_b32 v144, 0
    v_mov_b32 v145, 0
    v_mov_b32 v146, 0
    v_mov_b32 v147, 0
    v_mov_b32 v148, 0
    v_mov_b32 v149, 0
    v_mov_b32 v150, 0
    v_mov_b32 v151, 0
    ds_read_b128 v[64:67], v36 offset:0
    ds_read_b64_tr_b16 v[72:73], v40 offset:0
    ds_read_b64_tr_b16 v[74:75], v40 offset:3328
    ds_read_b64_tr_b16 v[76:77], v40 offset:32
    ds_read_b64_tr_b16 v[78:79], v40 offset:3360
    ds_read_b64_tr_b16 v[80:81], v40 offset:64
    ds_read_b64_tr_b16 v[82:83], v40 offset:3392
    ds_read_b64_tr_b16 v[84:85], v40 offset:96
    ds_read_b64_tr_b16 v[86:87], v40 offset:3424
    ds_read_b64_tr_b16 v[88:89], v40 offset:128
    ds_read_b64_tr_b16 v[90:91], v40 offset:3456
    ds_read_b64_tr_b16 v[92:93], v40 offset:160
    ds_read_b64_tr_b16 v[94:95], v40 offset:3488
    s_waitcnt lgkmcnt(10)
    v_mfma_f32_16x16x32_bf16 v[128:131], v[72:75], v[64:67], v[128:131]
    s_waitcnt lgkmcnt(8)
    v_mfma_f32_16x16x32_bf16 v[132:135], v[76:79], v[64:67], v[132:135]
    s_waitcnt lgkmcnt(6)
    v_mfma_f32_16x16x32_bf16 v[136:139], v[80:83], v[64:67], v[136:139]
    s_waitcnt lgkmcnt(4)
    v_mfma_f32_16x16x32_bf16 v[140:143], v[84:87], v[64:67], v[140:143]
    s_waitcnt lgkmcnt(2)
    v_mfma_f32_16x16x32_bf16 v[144:147], v[64:67], v[88:91], v[144:147]
    s_waitcnt lgkmcnt(0)
    v_mfma_f32_16x16x32_bf16 v[148:151], v[64:67], v[92:95], v[148:151]
    ds_read_b128 v[64:67], v37 offset:0
    ds_read_b64_tr_b16 v[72:73], v40 offset:13312
    ds_read_b64_tr_b16 v[74:75], v40 offset:16640
    ds_read_b64_tr_b16 v[76:77], v40 offset:13344
    ds_read_b64_tr_b16 v[78:79], v40 offset:16672
    ds_read_b64_tr_b16 v[80:81], v40 offset:13376
    ds_read_b64_tr_b16 v[82:83], v40 offset:16704
    ds_read_b64_tr_b16 v[84:85], v40 offset:13408
    ds_read_b64_tr_b16 v[86:87], v40 offset:16736
    ds_read_b64_tr_b16 v[88:89], v40 offset:13440
    ds_read_b64_tr_b16 v[90:91], v40 offset:16768
    ds_read_b64_tr_b16 v[92:93], v40 offset:13472
    ds_read_b64_tr_b16 v[94:95], v40 offset:16800
    s_waitcnt lgkmcnt(10)
    v_mfma_f32_16x16x32_bf16 v[128:131], v[72:75], v[64:67], v[128:131]
    s_waitcnt lgkmcnt(8)
    v_mfma_f32_16x16x32_bf16 v[132:135], v[76:79], v[64:67], v[132:135]
    s_waitcnt lgkmcnt(6)
    v_mfma_f32_16x16x32_bf16 v[136:139], v[80:83], v[64:67], v[136:139]
    s_waitcnt lgkmcnt(4)
    v_mfma_f32_16x16x32_bf16 v[140:143], v[84:87], v[64:67], v[140:143]
    s_waitcnt lgkmcnt(2)
    v_mfma_f32_16x16x32_bf16 v[144:147], v[64:67], v[88:91], v[144:147]
    s_waitcnt lgkmcnt(0)
    v_mfma_f32_16x16x32_bf16 v[148:151], v[64:67], v[92:95], v[148:151]
    s_waitcnt vmcnt(6)
    ds_write_b128 v16, v[212:215] offset:26624
    ds_write_b128 v17, v[216:219] offset:26624
    ds_write_b128 v18, v[220:223] offset:26624
    s_mov_b32 s35, 786432
    buffer_load_dwordx4 v[212:215], v8, s[16:19], s35 offen
    buffer_load_dwordx4 v[216:219], v9, s[16:19], s35 offen
    buffer_load_dwordx4 v[220:223], v10, s[16:19], s35 offen
    s_waitcnt lgkmcnt(0)
    s_barrier
    ds_read_b128 v[64:67], v38 offset:0
    ds_read_b64_tr_b16 v[72:73], v40 offset:26624
    ds_read_b64_tr_b16 v[74:75], v40 offset:29952
    ds_read_b64_tr_b16 v[76:77], v40 offset:26656
    ds_read_b64_tr_b16 v[78:79], v40 offset:29984
    ds_read_b64_tr_b16 v[80:81], v40 offset:26688
    ds_read_b64_tr_b16 v[82:83], v40 offset:30016
    ds_read_b64_tr_b16 v[84:85], v40 offset:26720
    ds_read_b64_tr_b16 v[86:87], v40 offset:30048
    ds_read_b64_tr_b16 v[88:89], v40 offset:26752
    ds_read_b64_tr_b16 v[90:91], v40 offset:30080
    ds_read_b64_tr_b16 v[92:93], v40 offset:26784
    ds_read_b64_tr_b16 v[94:95], v40 offset:30112
    s_waitcnt lgkmcnt(10)
    v_mfma_f32_16x16x32_bf16 v[128:131], v[72:75], v[64:67], v[128:131]
    s_waitcnt lgkmcnt(8)
    v_mfma_f32_16x16x32_bf16 v[132:135], v[76:79], v[64:67], v[132:135]
    s_waitcnt lgkmcnt(6)
    v_mfma_f32_16x16x32_bf16 v[136:139], v[80:83], v[64:67], v[136:139]
    s_waitcnt lgkmcnt(4)
    v_mfma_f32_16x16x32_bf16 v[140:143], v[84:87], v[64:67], v[140:143]
    s_waitcnt lgkmcnt(2)
    v_mfma_f32_16x16x32_bf16 v[144:147], v[64:67], v[88:91], v[144:147]
    s_waitcnt lgkmcnt(0)
    v_mfma_f32_16x16x32_bf16 v[148:151], v[64:67], v[92:95], v[148:151]
    ds_read_b128 v[64:67], v39 offset:0
    ds_read_b64_tr_b16 v[72:73], v40 offset:39936
    ds_read_b64_tr_b16 v[74:75], v40 offset:43264
    ds_read_b64_tr_b16 v[76:77], v40 offset:39968
    ds_read_b64_tr_b16 v[78:79], v40 offset:43296
    ds_read_b64_tr_b16 v[80:81], v40 offset:40000
    ds_read_b64_tr_b16 v[82:83], v40 offset:43328
    ds_read_b64_tr_b16 v[84:85], v40 offset:40032
    ds_read_b64_tr_b16 v[86:87], v40 offset:43360
    ds_read_b64_tr_b16 v[88:89], v40 offset:40064
    ds_read_b64_tr_b16 v[90:91], v40 offset:43392
    ds_read_b64_tr_b16 v[92:93], v40 offset:40096
    ds_read_b64_tr_b16 v[94:95], v40 offset:43424
    s_waitcnt lgkmcnt(10)
    v_mfma_f32_16x16x32_bf16 v[128:131], v[72:75], v[64:67], v[128:131]
    s_waitcnt lgkmcnt(8)
    v_mfma_f32_16x16x32_bf16 v[132:135], v[76:79], v[64:67], v[132:135]
    s_waitcnt lgkmcnt(6)
    v_mfma_f32_16x16x32_bf16 v[136:139], v[80:83], v[64:67], v[136:139]
    s_waitcnt lgkmcnt(4)
    v_mfma_f32_16x16x32_bf16 v[140:143], v[84:87], v[64:67], v[140:143]
    s_waitcnt lgkmcnt(2)
    v_mfma_f32_16x16x32_bf16 v[144:147], v[64:67], v[88:91], v[144:147]
    s_waitcnt lgkmcnt(0)
    v_mfma_f32_16x16x32_bf16 v[148:151], v[64:67], v[92:95], v[148:151]
    s_waitcnt vmcnt(6)
    ds_write_b128 v16, v[100:103] offset:0
    ds_write_b128 v17, v[104:107] offset:0
    ds_write_b128 v18, v[108:111] offset:0
    s_mov_b32 s35, 983040
    buffer_load_dwordx4 v[100:103], v8, s[16:19], s35 offen
    buffer_load_dwordx4 v[104:107], v9, s[16:19], s35 offen
    buffer_load_dwordx4 v[108:111], v10, s[16:19], s35 offen
    s_waitcnt lgkmcnt(0)
    s_barrier
    ds_read_b128 v[64:67], v36 offset:256
    ds_read_b64_tr_b16 v[72:73], v40 offset:0
    ds_read_b64_tr_b16 v[74:75], v40 offset:3328
    ds_read_b64_tr_b16 v[76:77], v40 offset:32
    ds_read_b64_tr_b16 v[78:79], v40 offset:3360
    ds_read_b64_tr_b16 v[80:81], v40 offset:64
    ds_read_b64_tr_b16 v[82:83], v40 offset:3392
    ds_read_b64_tr_b16 v[84:85], v40 offset:96
    ds_read_b64_tr_b16 v[86:87], v40 offset:3424
    ds_read_b64_tr_b16 v[88:89], v40 offset:128
    ds_read_b64_tr_b16 v[90:91], v40 offset:3456
    ds_read_b64_tr_b16 v[92:93], v40 offset:160
    ds_read_b64_tr_b16 v[94:95], v40 offset:3488
    s_waitcnt lgkmcnt(10)
    v_mfma_f32_16x16x32_bf16 v[128:131], v[72:75], v[64:67], v[128:131]
    s_waitcnt lgkmcnt(8)
    v_mfma_f32_16x16x32_bf16 v[132:135], v[76:79], v[64:67], v[132:135]
    s_waitcnt lgkmcnt(6)
    v_mfma_f32_16x16x32_bf16 v[136:139], v[80:83], v[64:67], v[136:139]
    s_waitcnt lgkmcnt(4)
    v_mfma_f32_16x16x32_bf16 v[140:143], v[84:87], v[64:67], v[140:143]
    s_waitcnt lgkmcnt(2)
    v_mfma_f32_16x16x32_bf16 v[144:147], v[64:67], v[88:91], v[144:147]
    s_waitcnt lgkmcnt(0)
    v_mfma_f32_16x16x32_bf16 v[148:151], v[64:67], v[92:95], v[148:151]
    ds_read_b128 v[64:67], v37 offset:256
    ds_read_b64_tr_b16 v[72:73], v40 offset:13312
    ds_read_b64_tr_b16 v[74:75], v40 offset:16640
    ds_read_b64_tr_b16 v[76:77], v40 offset:13344
    ds_read_b64_tr_b16 v[78:79], v40 offset:16672
    ds_read_b64_tr_b16 v[80:81], v40 offset:13376
    ds_read_b64_tr_b16 v[82:83], v40 offset:16704
    ds_read_b64_tr_b16 v[84:85], v40 offset:13408
    ds_read_b64_tr_b16 v[86:87], v40 offset:16736
    ds_read_b64_tr_b16 v[88:89], v40 offset:13440
    ds_read_b64_tr_b16 v[90:91], v40 offset:16768
    ds_read_b64_tr_b16 v[92:93], v40 offset:13472
    ds_read_b64_tr_b16 v[94:95], v40 offset:16800
    s_waitcnt lgkmcnt(10)
    v_mfma_f32_16x16x32_bf16 v[128:131], v[72:75], v[64:67], v[128:131]
    s_waitcnt lgkmcnt(8)
    v_mfma_f32_16x16x32_bf16 v[132:135], v[76:79], v[64:67], v[132:135]
    s_waitcnt lgkmcnt(6)
    v_mfma_f32_16x16x32_bf16 v[136:139], v[80:83], v[64:67], v[136:139]
    s_waitcnt lgkmcnt(4)
    v_mfma_f32_16x16x32_bf16 v[140:143], v[84:87], v[64:67], v[140:143]
    s_waitcnt lgkmcnt(2)
    v_mfma_f32_16x16x32_bf16 v[144:147], v[64:67], v[88:91], v[144:147]
    s_waitcnt lgkmcnt(0)
    v_mfma_f32_16x16x32_bf16 v[148:151], v[64:67], v[92:95], v[148:151]
    s_waitcnt vmcnt(6)
    ds_write_b128 v16, v[184:187] offset:26624
    ds_write_b128 v17, v[188:191] offset:26624
    ds_write_b128 v18, v[192:195] offset:26624
    s_mov_b32 s35, 1179648
    buffer_load_dwordx4 v[184:187], v8, s[16:19], s35 offen
    buffer_load_dwordx4 v[188:191], v9, s[16:19], s35 offen
    buffer_load_dwordx4 v[192:195], v10, s[16:19], s35 offen
    s_waitcnt lgkmcnt(0)
    s_barrier
    ds_read_b128 v[64:67], v38 offset:256
    ds_read_b64_tr_b16 v[72:73], v40 offset:26624
    ds_read_b64_tr_b16 v[74:75], v40 offset:29952
    ds_read_b64_tr_b16 v[76:77], v40 offset:26656
    ds_read_b64_tr_b16 v[78:79], v40 offset:29984
    ds_read_b64_tr_b16 v[80:81], v40 offset:26688
    ds_read_b64_tr_b16 v[82:83], v40 offset:30016
    ds_read_b64_tr_b16 v[84:85], v40 offset:26720
    ds_read_b64_tr_b16 v[86:87], v40 offset:30048
    ds_read_b64_tr_b16 v[88:89], v40 offset:26752
    ds_read_b64_tr_b16 v[90:91], v40 offset:30080
    ds_read_b64_tr_b16 v[92:93], v40 offset:26784
    ds_read_b64_tr_b16 v[94:95], v40 offset:30112
    s_waitcnt lgkmcnt(10)
    v_mfma_f32_16x16x32_bf16 v[128:131], v[72:75], v[64:67], v[128:131]
    s_waitcnt lgkmcnt(8)
    v_mfma_f32_16x16x32_bf16 v[132:135], v[76:79], v[64:67], v[132:135]
    s_waitcnt lgkmcnt(6)
    v_mfma_f32_16x16x32_bf16 v[136:139], v[80:83], v[64:67], v[136:139]
    s_waitcnt lgkmcnt(4)
    v_mfma_f32_16x16x32_bf16 v[140:143], v[84:87], v[64:67], v[140:143]
    s_waitcnt lgkmcnt(2)
    v_mfma_f32_16x16x32_bf16 v[144:147], v[64:67], v[88:91], v[144:147]
    s_waitcnt lgkmcnt(0)
    v_mfma_f32_16x16x32_bf16 v[148:151], v[64:67], v[92:95], v[148:151]
    ds_read_b128 v[64:67], v39 offset:256
    ds_read_b64_tr_b16 v[72:73], v40 offset:39936
    ds_read_b64_tr_b16 v[74:75], v40 offset:43264
    ds_read_b64_tr_b16 v[76:77], v40 offset:39968
    ds_read_b64_tr_b16 v[78:79], v40 offset:43296
    ds_read_b64_tr_b16 v[80:81], v40 offset:40000
    ds_read_b64_tr_b16 v[82:83], v40 offset:43328
    ds_read_b64_tr_b16 v[84:85], v40 offset:40032
    ds_read_b64_tr_b16 v[86:87], v40 offset:43360
    ds_read_b64_tr_b16 v[88:89], v40 offset:40064
    ds_read_b64_tr_b16 v[90:91], v40 offset:43392
    ds_read_b64_tr_b16 v[92:93], v40 offset:40096
    ds_read_b64_tr_b16 v[94:95], v40 offset:43424
    s_waitcnt lgkmcnt(10)
    v_mfma_f32_16x16x32_bf16 v[128:131], v[72:75], v[64:67], v[128:131]
    s_waitcnt lgkmcnt(8)
    v_mfma_f32_16x16x32_bf16 v[132:135], v[76:79], v[64:67], v[132:135]
    s_waitcnt lgkmcnt(6)
    v_mfma_f32_16x16x32_bf16 v[136:139], v[80:83], v[64:67], v[136:139]
    s_waitcnt lgkmcnt(4)
    v_mfma_f32_16x16x32_bf16 v[140:143], v[84:87], v[64:67], v[140:143]
    s_waitcnt lgkmcnt(2)
    v_mfma_f32_16x16x32_bf16 v[144:147], v[64:67], v[88:91], v[144:147]
    s_waitcnt lgkmcnt(0)
    v_mfma_f32_16x16x32_bf16 v[148:151], v[64:67], v[92:95], v[148:151]
    s_waitcnt vmcnt(6)
    ds_write_b128 v16, v[212:215] offset:0
    ds_write_b128 v17, v[216:219] offset:0
    ds_write_b128 v18, v[220:223] offset:0
    s_mov_b32 s35, 1376256
    buffer_load_dwordx4 v[212:215], v8, s[16:19], s35 offen
    buffer_load_dwordx4 v[216:219], v9, s[16:19], s35 offen
    buffer_load_dwordx4 v[220:223], v10, s[16:19], s35 offen
    s_waitcnt lgkmcnt(0)
    s_barrier
    ds_read_b128 v[64:67], v36 offset:512
    ds_read_b64_tr_b16 v[72:73], v40 offset:0
    ds_read_b64_tr_b16 v[74:75], v40 offset:3328
    ds_read_b64_tr_b16 v[76:77], v40 offset:32
    ds_read_b64_tr_b16 v[78:79], v40 offset:3360
    ds_read_b64_tr_b16 v[80:81], v40 offset:64
    ds_read_b64_tr_b16 v[82:83], v40 offset:3392
    ds_read_b64_tr_b16 v[84:85], v40 offset:96
    ds_read_b64_tr_b16 v[86:87], v40 offset:3424
    ds_read_b64_tr_b16 v[88:89], v40 offset:128
    ds_read_b64_tr_b16 v[90:91], v40 offset:3456
    ds_read_b64_tr_b16 v[92:93], v40 offset:160
    ds_read_b64_tr_b16 v[94:95], v40 offset:3488
    s_waitcnt lgkmcnt(10)
    v_mfma_f32_16x16x32_bf16 v[128:131], v[72:75], v[64:67], v[128:131]
    s_waitcnt lgkmcnt(8)
    v_mfma_f32_16x16x32_bf16 v[132:135], v[76:79], v[64:67], v[132:135]
    s_waitcnt lgkmcnt(6)
    v_mfma_f32_16x16x32_bf16 v[136:139], v[80:83], v[64:67], v[136:139]
    s_waitcnt lgkmcnt(4)
    v_mfma_f32_16x16x32_bf16 v[140:143], v[84:87], v[64:67], v[140:143]
    s_waitcnt lgkmcnt(2)
    v_mfma_f32_16x16x32_bf16 v[144:147], v[64:67], v[88:91], v[144:147]
    s_waitcnt lgkmcnt(0)
    v_mfma_f32_16x16x32_bf16 v[148:151], v[64:67], v[92:95], v[148:151]
    ds_read_b128 v[64:67], v37 offset:512
    ds_read_b64_tr_b16 v[72:73], v40 offset:13312
    ds_read_b64_tr_b16 v[74:75], v40 offset:16640
    ds_read_b64_tr_b16 v[76:77], v40 offset:13344
    ds_read_b64_tr_b16 v[78:79], v40 offset:16672
    ds_read_b64_tr_b16 v[80:81], v40 offset:13376
    ds_read_b64_tr_b16 v[82:83], v40 offset:16704
    ds_read_b64_tr_b16 v[84:85], v40 offset:13408
    ds_read_b64_tr_b16 v[86:87], v40 offset:16736
    ds_read_b64_tr_b16 v[88:89], v40 offset:13440
    ds_read_b64_tr_b16 v[90:91], v40 offset:16768
    ds_read_b64_tr_b16 v[92:93], v40 offset:13472
    ds_read_b64_tr_b16 v[94:95], v40 offset:16800
    s_waitcnt lgkmcnt(10)
    v_mfma_f32_16x16x32_bf16 v[128:131], v[72:75], v[64:67], v[128:131]
    s_waitcnt lgkmcnt(8)
    v_mfma_f32_16x16x32_bf16 v[132:135], v[76:79], v[64:67], v[132:135]
    s_waitcnt lgkmcnt(6)
    v_mfma_f32_16x16x32_bf16 v[136:139], v[80:83], v[64:67], v[136:139]
    s_waitcnt lgkmcnt(4)
    v_mfma_f32_16x16x32_bf16 v[140:143], v[84:87], v[64:67], v[140:143]
    s_waitcnt lgkmcnt(2)
    v_mfma_f32_16x16x32_bf16 v[144:147], v[64:67], v[88:91], v[144:147]
    s_waitcnt lgkmcnt(0)
    v_mfma_f32_16x16x32_bf16 v[148:151], v[64:67], v[92:95], v[148:151]
    s_waitcnt vmcnt(6)
    ds_write_b128 v16, v[100:103] offset:26624
    ds_write_b128 v17, v[104:107] offset:26624
    ds_write_b128 v18, v[108:111] offset:26624
    s_waitcnt lgkmcnt(0)
    s_barrier
    ds_read_b128 v[64:67], v38 offset:512
    ds_read_b64_tr_b16 v[72:73], v40 offset:26624
    ds_read_b64_tr_b16 v[74:75], v40 offset:29952
    ds_read_b64_tr_b16 v[76:77], v40 offset:26656
    ds_read_b64_tr_b16 v[78:79], v40 offset:29984
    ds_read_b64_tr_b16 v[80:81], v40 offset:26688
    ds_read_b64_tr_b16 v[82:83], v40 offset:30016
    ds_read_b64_tr_b16 v[84:85], v40 offset:26720
    ds_read_b64_tr_b16 v[86:87], v40 offset:30048
    ds_read_b64_tr_b16 v[88:89], v40 offset:26752
    ds_read_b64_tr_b16 v[90:91], v40 offset:30080
    ds_read_b64_tr_b16 v[92:93], v40 offset:26784
    ds_read_b64_tr_b16 v[94:95], v40 offset:30112
    s_waitcnt lgkmcnt(10)
    v_mfma_f32_16x16x32_bf16 v[128:131], v[72:75], v[64:67], v[128:131]
    s_waitcnt lgkmcnt(8)
    v_mfma_f32_16x16x32_bf16 v[132:135], v[76:79], v[64:67], v[132:135]
    s_waitcnt lgkmcnt(6)
    v_mfma_f32_16x16x32_bf16 v[136:139], v[80:83], v[64:67], v[136:139]
    s_waitcnt lgkmcnt(4)
    v_mfma_f32_16x16x32_bf16 v[140:143], v[84:87], v[64:67], v[140:143]
    s_waitcnt lgkmcnt(2)
    v_mfma_f32_16x16x32_bf16 v[144:147], v[64:67], v[88:91], v[144:147]
    s_waitcnt lgkmcnt(0)
    v_mfma_f32_16x16x32_bf16 v[148:151], v[64:67], v[92:95], v[148:151]
    ds_read_b128 v[64:67], v39 offset:512
    ds_read_b64_tr_b16 v[72:73], v40 offset:39936
    ds_read_b64_tr_b16 v[74:75], v40 offset:43264
    ds_read_b64_tr_b16 v[76:77], v40 offset:39968
    ds_read_b64_tr_b16 v[78:79], v40 offset:43296
    ds_read_b64_tr_b16 v[80:81], v40 offset:40000
    ds_read_b64_tr_b16 v[82:83], v40 offset:43328
    ds_read_b64_tr_b16 v[84:85], v40 offset:40032
    ds_read_b64_tr_b16 v[86:87], v40 offset:43360
    ds_read_b64_tr_b16 v[88:89], v40 offset:40064
    ds_read_b64_tr_b16 v[90:91], v40 offset:43392
    ds_read_b64_tr_b16 v[92:93], v40 offset:40096
    ds_read_b64_tr_b16 v[94:95], v40 offset:43424
    s_waitcnt lgkmcnt(10)
    v_mfma_f32_16x16x32_bf16 v[128:131], v[72:75], v[64:67], v[128:131]
    s_waitcnt lgkmcnt(8)
    v_mfma_f32_16x16x32_bf16 v[132:135], v[76:79], v[64:67], v[132:135]
    s_waitcnt lgkmcnt(6)
    v_mfma_f32_16x16x32_bf16 v[136:139], v[80:83], v[64:67], v[136:139]
    s_waitcnt lgkmcnt(4)
    v_mfma_f32_16x16x32_bf16 v[140:143], v[84:87], v[64:67], v[140:143]
    s_waitcnt lgkmcnt(2)
    v_mfma_f32_16x16x32_bf16 v[144:147], v[64:67], v[88:91], v[144:147]
    s_waitcnt lgkmcnt(0)
    v_mfma_f32_16x16x32_bf16 v[148:151], v[64:67], v[92:95], v[148:151]
    s_waitcnt vmcnt(3)
    ds_write_b128 v16, v[184:187] offset:0
    ds_write_b128 v17, v[188:191] offset:0
    ds_write_b128 v18, v[192:195] offset:0
    s_waitcnt lgkmcnt(0)
    s_barrier
    ds_read_b128 v[64:67], v36 offset:768
    ds_read_b64_tr_b16 v[72:73], v40 offset:0
    ds_read_b64_tr_b16 v[74:75], v40 offset:3328
    ds_read_b64_tr_b16 v[76:77], v40 offset:32
    ds_read_b64_tr_b16 v[78:79], v40 offset:3360
    ds_read_b64_tr_b16 v[80:81], v40 offset:64
    ds_read_b64_tr_b16 v[82:83], v40 offset:3392
    ds_read_b64_tr_b16 v[84:85], v40 offset:96
    ds_read_b64_tr_b16 v[86:87], v40 offset:3424
    ds_read_b64_tr_b16 v[88:89], v40 offset:128
    ds_read_b64_tr_b16 v[90:91], v40 offset:3456
    ds_read_b64_tr_b16 v[92:93], v40 offset:160
    ds_read_b64_tr_b16 v[94:95], v40 offset:3488
    s_waitcnt lgkmcnt(10)
    v_mfma_f32_16x16x32_bf16 v[128:131], v[72:75], v[64:67], v[128:131]
    s_waitcnt lgkmcnt(8)
    v_mfma_f32_16x16x32_bf16 v[132:135], v[76:79], v[64:67], v[132:135]
    s_waitcnt lgkmcnt(6)
    v_mfma_f32_16x16x32_bf16 v[136:139], v[80:83], v[64:67], v[136:139]
    s_waitcnt lgkmcnt(4)
    v_mfma_f32_16x16x32_bf16 v[140:143], v[84:87], v[64:67], v[140:143]
    s_waitcnt lgkmcnt(2)
    v_mfma_f32_16x16x32_bf16 v[144:147], v[64:67], v[88:91], v[144:147]
    s_waitcnt lgkmcnt(0)
    v_mfma_f32_16x16x32_bf16 v[148:151], v[64:67], v[92:95], v[148:151]
    ds_read_b128 v[64:67], v37 offset:768
    ds_read_b64_tr_b16 v[72:73], v40 offset:13312
    ds_read_b64_tr_b16 v[74:75], v40 offset:16640
    ds_read_b64_tr_b16 v[76:77], v40 offset:13344
    ds_read_b64_tr_b16 v[78:79], v40 offset:16672
    ds_read_b64_tr_b16 v[80:81], v40 offset:13376
    ds_read_b64_tr_b16 v[82:83], v40 offset:16704
    ds_read_b64_tr_b16 v[84:85], v40 offset:13408
    ds_read_b64_tr_b16 v[86:87], v40 offset:16736
    ds_read_b64_tr_b16 v[88:89], v40 offset:13440
    ds_read_b64_tr_b16 v[90:91], v40 offset:16768
    ds_read_b64_tr_b16 v[92:93], v40 offset:13472
    ds_read_b64_tr_b16 v[94:95], v40 offset:16800
    s_waitcnt lgkmcnt(10)
    v_mfma_f32_16x16x32_bf16 v[128:131], v[72:75], v[64:67], v[128:131]
    s_waitcnt lgkmcnt(8)
    v_mfma_f32_16x16x32_bf16 v[132:135], v[76:79], v[64:67], v[132:135]
    s_waitcnt lgkmcnt(6)
    v_mfma_f32_16x16x32_bf16 v[136:139], v[80:83], v[64:67], v[136:139]
    s_waitcnt lgkmcnt(4)
    v_mfma_f32_16x16x32_bf16 v[140:143], v[84:87], v[64:67], v[140:143]
    s_waitcnt lgkmcnt(2)
    v_mfma_f32_16x16x32_bf16 v[144:147], v[64:67], v[88:91], v[144:147]
    s_waitcnt lgkmcnt(0)
    v_mfma_f32_16x16x32_bf16 v[148:151], v[64:67], v[92:95], v[148:151]
    s_waitcnt vmcnt(0)
    ds_write_b128 v16, v[212:215] offset:26624
    ds_write_b128 v17, v[216:219] offset:26624
    ds_write_b128 v18, v[220:223] offset:26624
    s_waitcnt lgkmcnt(0)
    s_barrier
    ds_read_b128 v[64:67], v38 offset:768
    ds_read_b64_tr_b16 v[72:73], v40 offset:26624
    ds_read_b64_tr_b16 v[74:75], v40 offset:29952
    ds_read_b64_tr_b16 v[76:77], v40 offset:26656
    ds_read_b64_tr_b16 v[78:79], v40 offset:29984
    ds_read_b64_tr_b16 v[80:81], v40 offset:26688
    ds_read_b64_tr_b16 v[82:83], v40 offset:30016
    ds_read_b64_tr_b16 v[84:85], v40 offset:26720
    ds_read_b64_tr_b16 v[86:87], v40 offset:30048
    ds_read_b64_tr_b16 v[88:89], v40 offset:26752
    ds_read_b64_tr_b16 v[90:91], v40 offset:30080
    ds_read_b64_tr_b16 v[92:93], v40 offset:26784
    ds_read_b64_tr_b16 v[94:95], v40 offset:30112
    s_waitcnt lgkmcnt(10)
    v_mfma_f32_16x16x32_bf16 v[128:131], v[72:75], v[64:67], v[128:131]
    s_waitcnt lgkmcnt(8)
    v_mfma_f32_16x16x32_bf16 v[132:135], v[76:79], v[64:67], v[132:135]
    s_waitcnt lgkmcnt(6)
    v_mfma_f32_16x16x32_bf16 v[136:139], v[80:83], v[64:67], v[136:139]
    s_waitcnt lgkmcnt(4)
    v_mfma_f32_16x16x32_bf16 v[140:143], v[84:87], v[64:67], v[140:143]
    s_waitcnt lgkmcnt(2)
    v_mfma_f32_16x16x32_bf16 v[144:147], v[64:67], v[88:91], v[144:147]
    s_waitcnt lgkmcnt(0)
    v_mfma_f32_16x16x32_bf16 v[148:151], v[64:67], v[92:95], v[148:151]
    ds_read_b128 v[64:67], v39 offset:768
    ds_read_b64_tr_b16 v[72:73], v40 offset:39936
    ds_read_b64_tr_b16 v[74:75], v40 offset:43264
    ds_read_b64_tr_b16 v[76:77], v40 offset:39968
    ds_read_b64_tr_b16 v[78:79], v40 offset:43296
    ds_read_b64_tr_b16 v[80:81], v40 offset:40000
    ds_read_b64_tr_b16 v[82:83], v40 offset:43328
    ds_read_b64_tr_b16 v[84:85], v40 offset:40032
    ds_read_b64_tr_b16 v[86:87], v40 offset:43360
    ds_read_b64_tr_b16 v[88:89], v40 offset:40064
    ds_read_b64_tr_b16 v[90:91], v40 offset:43392
    ds_read_b64_tr_b16 v[92:93], v40 offset:40096
    ds_read_b64_tr_b16 v[94:95], v40 offset:43424
    s_waitcnt lgkmcnt(10)
    v_mfma_f32_16x16x32_bf16 v[128:131], v[72:75], v[64:67], v[128:131]
    s_waitcnt lgkmcnt(8)
    v_mfma_f32_16x16x32_bf16 v[132:135], v[76:79], v[64:67], v[132:135]
    s_waitcnt lgkmcnt(6)
    v_mfma_f32_16x16x32_bf16 v[136:139], v[80:83], v[64:67], v[136:139]
    s_waitcnt lgkmcnt(4)
    v_mfma_f32_16x16x32_bf16 v[140:143], v[84:87], v[64:67], v[140:143]
    s_waitcnt lgkmcnt(2)
    v_mfma_f32_16x16x32_bf16 v[144:147], v[64:67], v[88:91], v[144:147]
    s_waitcnt lgkmcnt(0)
    v_mfma_f32_16x16x32_bf16 v[148:151], v[64:67], v[92:95], v[148:151]
    s_nop 7
    s_lshr_b32 s37, s30, 1
    s_lshl_b32 s37, s37, 4
    s_add_u32 s37, s37, s28
    s_and_b32 s38, s30, 1
    s_mul_i32 s38, s38, 96
    s_add_u32 s38, s38, s29
    s_lshl_b32 s38, s38, 12
    v_add_u32 v5, s37, v4
    v_lshlrev_b32 v5, 5, v5
    v_lshl_add_u32 v5, v3, 3, v5
    s_lshl_b32 s37, s37, 5
    v_lshlrev_b32 v7, 5, v4
    v_lshl_add_u32 v7, v3, 3, v7
    v_add_u32 v7, s37, v7
    v_cvt_pk_bf16_f32 v128, v128, v129
    v_cvt_pk_bf16_f32 v129, v130, v131
    s_add_u32 s44, s38, 0
    buffer_store_dwordx2 v[128:129], v5, s[20:23], s44 offen offset:0
    v_cvt_pk_bf16_f32 v132, v132, v133
    v_cvt_pk_bf16_f32 v133, v134, v135
    s_add_u32 s44, s38, 65536
    buffer_store_dwordx2 v[132:133], v5, s[20:23], s44 offen offset:0
    v_cvt_pk_bf16_f32 v136, v136, v137
    v_cvt_pk_bf16_f32 v137, v138, v139
    s_add_u32 s44, s38, 131072
    buffer_store_dwordx2 v[136:137], v5, s[20:23], s44 offen offset:0
    v_cvt_pk_bf16_f32 v140, v140, v141
    v_cvt_pk_bf16_f32 v141, v142, v143
    s_add_u32 s44, s38, 196608
    buffer_store_dwordx2 v[140:141], v5, s[20:23], s44 offen offset:0
    v_cvt_pk_bf16_f32 v144, v144, v145
    v_cvt_pk_bf16_f32 v145, v146, v147
    s_add_u32 s44, s38, -3932160
    buffer_store_dwordx2 v[144:145], v7, s[24:27], s44 offen offset:0
    v_cvt_pk_bf16_f32 v148, v148, v149
    v_cvt_pk_bf16_f32 v149, v150, v151
    s_add_u32 s44, s38, -3866624
    buffer_store_dwordx2 v[148:149], v7, s[24:27], s44 offen offset:0
    s_endpgm
k1_qkv_kernel_end:
    s_endpgm
.p2align 8
.globl k2_attn_kernel
.type k2_attn_kernel,@function
k2_attn_kernel:
    s_cmp_ge_u32 s2, 1024
    s_cbranch_scc1 k2_attn_kernel_end
    s_load_dwordx2 s[8:9], s[0:1], 80
    v_and_b32 v1, 63, v0
    v_lshrrev_b32 v2, 6, v0
    s_nop 0
    v_readfirstlane_b32 s30, v2
    s_lshr_b32 s28, s2, 3
    s_lshl_b32 s28, s28, 4
    s_and_b32 s29, s2, 7
    s_lshl_b32 s29, s29, 2
    s_add_u32 s29, s29, s30
    s_waitcnt lgkmcnt(0)
    s_mov_b32 s12, s8
    s_and_b32 s13, s9, 0xffff
    s_mov_b32 s14, 0x400000
    s_mov_b32 s15, 0x00020000
    s_add_u32 s16, s8, 0x3fe000
    s_addc_u32 s17, s9, 0
    s_and_b32 s17, s17, 0xffff
    s_mov_b32 s18, 0x202000
    s_mov_b32 s19, 0x00020000
    s_add_u32 s20, s8, 0x600000
    s_addc_u32 s21, s9, 0
    s_and_b32 s21, s21, 0xffff
    s_mov_b32 s22, 0x200000
    s_mov_b32 s23, 0x00020000
    s_mov_b32 s40, 4096
    s_mov_b32 s41, 8192
    v_lshrrev_b32 v3, 4, v1
    v_and_b32 v4, 15, v1
    v_add_u32 v5, s28, v4
    v_lshlrev_b32 v5, 5, v5
    v_lshl_add_u32 v5, v3, 3, v5
    s_lshl_b32 s31, s29, 16
    v_add_u32 v5, s31, v5
    buffer_load_dwordx2 v[10:11], v5, s[12:15], 0 offen
    v_add_u32 v6, 2088960, v5
    buffer_load_dwordx2 v[16:17], v6, s[12:15], 0 offen offset:0
    buffer_load_dwordx2 v[18:19], v6, s[12:15], 0 offen offset:512
    buffer_load_dwordx2 v[20:21], v6, s[12:15], 0 offen offset:1024
    buffer_load_dwordx2 v[22:23], v6, s[12:15], 0 offen offset:1536
    buffer_load_dwordx2 v[24:25], v6, s[12:15], 0 offen offset:2048
    buffer_load_dwordx2 v[26:27], v6, s[12:15], 0 offen offset:2560
    buffer_load_dwordx2 v[28:29], v6, s[12:15], 0 offen offset:3072
    buffer_load_dwordx2 v[30:31], v6, s[12:15], 0 offen offset:3584
    buffer_load_dwordx2 v[32:33], v6, s[12:15], s40 offen offset:0
    buffer_load_dwordx2 v[34:35], v6, s[12:15], s40 offen offset:512
    buffer_load_dwordx2 v[36:37], v6, s[12:15], s40 offen offset:1024
    buffer_load_dwordx2 v[38:39], v6, s[12:15], s40 offen offset:1536
    buffer_load_dwordx2 v[40:41], v6, s[12:15], s40 offen offset:2048
    buffer_load_dwordx2 v[42:43], v6, s[12:15], s40 offen offset:2560
    buffer_load_dwordx2 v[44:45], v6, s[12:15], s40 offen offset:3072
    buffer_load_dwordx2 v[46:47], v6, s[12:15], s40 offen offset:3584
    buffer_load_dwordx2 v[48:49], v6, s[12:15], s41 offen offset:0
    s_lshl_b32 s32, s28, 5
    s_add_u32 s31, s31, s32
    v_lshlrev_b32 v8, 5, v4
    v_lshl_add_u32 v8, v3, 3, v8
    v_add_u32 v8, s31, v8
    buffer_load_dwordx2 v[52:53], v8, s[16:19], 0 offen offset:0
    buffer_load_dwordx2 v[54:55], v8, s[16:19], 0 offen offset:512
    buffer_load_dwordx2 v[56:57], v8, s[16:19], 0 offen offset:1024
    buffer_load_dwordx2 v[58:59], v8, s[16:19], 0 offen offset:1536
    buffer_load_dwordx2 v[60:61], v8, s[16:19], 0 offen offset:2048
    buffer_load_dwordx2 v[62:63], v8, s[16:19], 0 offen offset:2560
    buffer_load_dwordx2 v[64:65], v8, s[16:19], 0 offen offset:3072
    buffer_load_dwordx2 v[66:67], v8, s[16:19], 0 offen offset:3584
    buffer_load_dwordx2 v[68:69], v8, s[16:19], s40 offen offset:0
    buffer_load_dwordx2 v[70:71], v8, s[16:19], s40 offen offset:512
    buffer_load_dwordx2 v[72:73], v8, s[16:19], s40 offen offset:1024
    buffer_load_dwordx2 v[74:75], v8, s[16:19], s40 offen offset:1536
    buffer_load_dwordx2 v[76:77], v8, s[16:19], s40 offen offset:2048
    buffer_load_dwordx2 v[78:79], v8, s[16:19], s40 offen offset:2560
    buffer_load_dwordx2 v[80:81], v8, s[16:19], s40 offen offset:3072
    buffer_load_dwordx2 v[82:83], v8, s[16:19], s40 offen offset:3584
    buffer_load_dwordx2 v[84:85], v8, s[16:19], s41 offen offset:0
    buffer_load_dwordx2 v[86:87], v8, s[16:19], s41 offen offset:512
    v_mov_b32 v12, 0
    v_mov_b32 v13, 0
    v_mov_b32 v14, 0
    v_mov_b32 v15, 0
    s_waitcnt vmcnt(34)
    s_nop 0
    v_mfma_f32_16x16x16_bf16 v[96:99], v[16:17], v[10:11], v[12:15]
    s_waitcnt vmcnt(33)
    v_mfma_f32_16x16x16_bf16 v[100:103], v[18:19], v[10:11], v[12:15]
    s_waitcnt vmcnt(32)
    v_mfma_f32_16x16x16_bf16 v[104:107], v[20:21], v[10:11], v[12:15]
    s_waitcnt vmcnt(31)
    v_mfma_f32_16x16x16_bf16 v[108:111], v[22:23], v[10:11], v[12:15]
    s_waitcnt vmcnt(30)
    v_mfma_f32_16x16x16_bf16 v[112:115], v[24:25], v[10:11], v[12:15]
    s_waitcnt vmcnt(29)
    v_mfma_f32_16x16x16_bf16 v[116:119], v[26:27], v[10:11], v[12:15]
    s_waitcnt vmcnt(28)
    v_mfma_f32_16x16x16_bf16 v[120:123], v[28:29], v[10:11], v[12:15]
    s_waitcnt vmcnt(27)
    v_mfma_f32_16x16x16_bf16 v[124:127], v[30:31], v[10:11], v[12:15]
    s_waitcnt vmcnt(26)
    v_mfma_f32_16x16x16_bf16 v[128:131], v[32:33], v[10:11], v[12:15]
    s_waitcnt vmcnt(25)
    v_mfma_f32_16x16x16_bf16 v[132:135], v[34:35], v[10:11], v[12:15]
    s_waitcnt vmcnt(24)
    v_mfma_f32_16x16x16_bf16 v[136:139], v[36:37], v[10:11], v[12:15]
    s_waitcnt vmcnt(23)
    v_mfma_f32_16x16x16_bf16 v[140:143], v[38:39], v[10:11], v[12:15]
    s_waitcnt vmcnt(22)
    v_mfma_f32_16x16x16_bf16 v[144:147], v[40:41], v[10:11], v[12:15]
    s_waitcnt vmcnt(21)
    v_mfma_f32_16x16x16_bf16 v[148:151], v[42:43], v[10:11], v[12:15]
    s_waitcnt vmcnt(20)
    v_mfma_f32_16x16x16_bf16 v[152:155], v[44:45], v[10:11], v[12:15]
    s_waitcnt vmcnt(19)
    v_mfma_f32_16x16x16_bf16 v[156:159], v[46:47], v[10:11], v[12:15]
    s_waitcnt vmcnt(18)
    v_mfma_f32_16x16x16_bf16 v[160:163], v[48:49], v[10:11], v[12:15]
    s_nop 7
    s_mov_b32 s33, 0xce6e6b28
    v_lshlrev_b32 v9, 2, v3
    v_cvt_pk_bf16_f32 v96, v96, v96
    v_lshlrev_b32 v96, 16, v96
    v_mul_f32 v96, 0.25, v96
    v_cvt_pk_bf16_f32 v97, v97, v97
    v_lshlrev_b32 v97, 16, v97
    v_mul_f32 v97, 0.25, v97
    v_cvt_pk_bf16_f32 v98, v98, v98
    v_lshlrev_b32 v98, 16, v98
    v_mul_f32 v98, 0.25, v98
    v_cvt_pk_bf16_f32 v99, v99, v99
    v_lshlrev_b32 v99, 16, v99
    v_mul_f32 v99, 0.25, v99
    v_cvt_pk_bf16_f32 v100, v100, v100
    v_lshlrev_b32 v100, 16, v100
    v_mul_f32 v100, 0.25, v100
    v_cvt_pk_bf16_f32 v101, v101, v101
    v_lshlrev_b32 v101, 16, v101
    v_mul_f32 v101, 0.25, v101
    v_cvt_pk_bf16_f32 v102, v102, v102
    v_lshlrev_b32 v102, 16, v102
    v_mul_f32 v102, 0.25, v102
    v_cvt_pk_bf16_f32 v103, v103, v103
    v_lshlrev_b32 v103, 16, v103
    v_mul_f32 v103, 0.25, v103
    v_cvt_pk_bf16_f32 v104, v104, v104
    v_lshlrev_b32 v104, 16, v104
    v_mul_f32 v104, 0.25, v104
    v_cvt_pk_bf16_f32 v105, v105, v105
    v_lshlrev_b32 v105, 16, v105
    v_mul_f32 v105, 0.25, v105
    v_cvt_pk_bf16_f32 v106, v106, v106
    v_lshlrev_b32 v106, 16, v106
    v_mul_f32 v106, 0.25, v106
    v_cvt_pk_bf16_f32 v107, v107, v107
    v_lshlrev_b32 v107, 16, v107
    v_mul_f32 v107, 0.25, v107
    v_cvt_pk_bf16_f32 v108, v108, v108
    v_lshlrev_b32 v108, 16, v108
    v_mul_f32 v108, 0.25, v108
    v_cvt_pk_bf16_f32 v109, v109, v109
    v_lshlrev_b32 v109, 16, v109
    v_mul_f32 v109, 0.25, v109
    v_cvt_pk_bf16_f32 v110, v110, v110
    v_lshlrev_b32 v110, 16, v110
    v_mul_f32 v110, 0.25, v110
    v_cvt_pk_bf16_f32 v111, v111, v111
    v_lshlrev_b32 v111, 16, v111
    v_mul_f32 v111, 0.25, v111
    v_cvt_pk_bf16_f32 v112, v112, v112
    v_lshlrev_b32 v112, 16, v112
    v_mul_f32 v112, 0.25, v112
    v_cvt_pk_bf16_f32 v113, v113, v113
    v_lshlrev_b32 v113, 16, v113
    v_mul_f32 v113, 0.25, v113
    v_cvt_pk_bf16_f32 v114, v114, v114
    v_lshlrev_b32 v114, 16, v114
    v_mul_f32 v114, 0.25, v114
    v_cvt_pk_bf16_f32 v115, v115, v115
    v_lshlrev_b32 v115, 16, v115
    v_mul_f32 v115, 0.25, v115
    v_cvt_pk_bf16_f32 v116, v116, v116
    v_lshlrev_b32 v116, 16, v116
    v_mul_f32 v116, 0.25, v116
    v_cvt_pk_bf16_f32 v117, v117, v117
    v_lshlrev_b32 v117, 16, v117
    v_mul_f32 v117, 0.25, v117
    v_cvt_pk_bf16_f32 v118, v118, v118
    v_lshlrev_b32 v118, 16, v118
    v_mul_f32 v118, 0.25, v118
    v_cvt_pk_bf16_f32 v119, v119, v119
    v_lshlrev_b32 v119, 16, v119
    v_mul_f32 v119, 0.25, v119
    v_cvt_pk_bf16_f32 v120, v120, v120
    v_lshlrev_b32 v120, 16, v120
    v_mul_f32 v120, 0.25, v120
    v_cvt_pk_bf16_f32 v121, v121, v121
    v_lshlrev_b32 v121, 16, v121
    v_mul_f32 v121, 0.25, v121
    v_cvt_pk_bf16_f32 v122, v122, v122
    v_lshlrev_b32 v122, 16, v122
    v_mul_f32 v122, 0.25, v122
    v_cvt_pk_bf16_f32 v123, v123, v123
    v_lshlrev_b32 v123, 16, v123
    v_mul_f32 v123, 0.25, v123
    v_cvt_pk_bf16_f32 v124, v124, v124
    v_lshlrev_b32 v124, 16, v124
    v_mul_f32 v124, 0.25, v124
    v_cvt_pk_bf16_f32 v125, v125, v125
    v_lshlrev_b32 v125, 16, v125
    v_mul_f32 v125, 0.25, v125
    v_cvt_pk_bf16_f32 v126, v126, v126
    v_lshlrev_b32 v126, 16, v126
    v_mul_f32 v126, 0.25, v126
    v_cvt_pk_bf16_f32 v127, v127, v127
    v_lshlrev_b32 v127, 16, v127
    v_mul_f32 v127, 0.25, v127
    v_cvt_pk_bf16_f32 v128, v128, v128
    v_lshlrev_b32 v128, 16, v128
    v_mul_f32 v128, 0.25, v128
    v_cvt_pk_bf16_f32 v129, v129, v129
    v_lshlrev_b32 v129, 16, v129
    v_mul_f32 v129, 0.25, v129
    v_cvt_pk_bf16_f32 v130, v130, v130
    v_lshlrev_b32 v130, 16, v130
    v_mul_f32 v130, 0.25, v130
    v_cvt_pk_bf16_f32 v131, v131, v131
    v_lshlrev_b32 v131, 16, v131
    v_mul_f32 v131, 0.25, v131
    v_cvt_pk_bf16_f32 v132, v132, v132
    v_lshlrev_b32 v132, 16, v132
    v_mul_f32 v132, 0.25, v132
    v_cvt_pk_bf16_f32 v133, v133, v133
    v_lshlrev_b32 v133, 16, v133
    v_mul_f32 v133, 0.25, v133
    v_cvt_pk_bf16_f32 v134, v134, v134
    v_lshlrev_b32 v134, 16, v134
    v_mul_f32 v134, 0.25, v134
    v_cvt_pk_bf16_f32 v135, v135, v135
    v_lshlrev_b32 v135, 16, v135
    v_mul_f32 v135, 0.25, v135
    v_cvt_pk_bf16_f32 v136, v136, v136
    v_lshlrev_b32 v136, 16, v136
    v_mul_f32 v136, 0.25, v136
    v_cvt_pk_bf16_f32 v137, v137, v137
    v_lshlrev_b32 v137, 16, v137
    v_mul_f32 v137, 0.25, v137
    v_cvt_pk_bf16_f32 v138, v138, v138
    v_lshlrev_b32 v138, 16, v138
    v_mul_f32 v138, 0.25, v138
    v_cvt_pk_bf16_f32 v139, v139, v139
    v_lshlrev_b32 v139, 16, v139
    v_mul_f32 v139, 0.25, v139
    v_cvt_pk_bf16_f32 v140, v140, v140
    v_lshlrev_b32 v140, 16, v140
    v_mul_f32 v140, 0.25, v140
    v_cvt_pk_bf16_f32 v141, v141, v141
    v_lshlrev_b32 v141, 16, v141
    v_mul_f32 v141, 0.25, v141
    v_cvt_pk_bf16_f32 v142, v142, v142
    v_lshlrev_b32 v142, 16, v142
    v_mul_f32 v142, 0.25, v142
    v_cvt_pk_bf16_f32 v143, v143, v143
    v_lshlrev_b32 v143, 16, v143
    v_mul_f32 v143, 0.25, v143
    v_cvt_pk_bf16_f32 v144, v144, v144
    v_lshlrev_b32 v144, 16, v144
    v_mul_f32 v144, 0.25, v144
    v_cvt_pk_bf16_f32 v145, v145, v145
    v_lshlrev_b32 v145, 16, v145
    v_mul_f32 v145, 0.25, v145
    v_cvt_pk_bf16_f32 v146, v146, v146
    v_lshlrev_b32 v146, 16, v146
    v_mul_f32 v146, 0.25, v146
    v_cvt_pk_bf16_f32 v147, v147, v147
    v_lshlrev_b32 v147, 16, v147
    v_mul_f32 v147, 0.25, v147
    v_cvt_pk_bf16_f32 v148, v148, v148
    v_lshlrev_b32 v148, 16, v148
    v_mul_f32 v148, 0.25, v148
    v_cvt_pk_bf16_f32 v149, v149, v149
    v_lshlrev_b32 v149, 16, v149
    v_mul_f32 v149, 0.25, v149
    v_cvt_pk_bf16_f32 v150, v150, v150
    v_lshlrev_b32 v150, 16, v150
    v_mul_f32 v150, 0.25, v150
    v_cvt_pk_bf16_f32 v151, v151, v151
    v_lshlrev_b32 v151, 16, v151
    v_mul_f32 v151, 0.25, v151
    v_cvt_pk_bf16_f32 v152, v152, v152
    v_lshlrev_b32 v152, 16, v152
    v_mul_f32 v152, 0.25, v152
    v_cvt_pk_bf16_f32 v153, v153, v153
    v_lshlrev_b32 v153, 16, v153
    v_mul_f32 v153, 0.25, v153
    v_cvt_pk_bf16_f32 v154, v154, v154
    v_lshlrev_b32 v154, 16, v154
    v_mul_f32 v154, 0.25, v154
    v_cvt_pk_bf16_f32 v155, v155, v155
    v_lshlrev_b32 v155, 16, v155
    v_mul_f32 v155, 0.25, v155
    v_cvt_pk_bf16_f32 v156, v156, v156
    v_lshlrev_b32 v156, 16, v156
    v_mul_f32 v156, 0.25, v156
    v_cvt_pk_bf16_f32 v157, v157, v157
    v_lshlrev_b32 v157, 16, v157
    v_mul_f32 v157, 0.25, v157
    v_cvt_pk_bf16_f32 v158, v158, v158
    v_lshlrev_b32 v158, 16, v158
    v_mul_f32 v158, 0.25, v158
    v_cvt_pk_bf16_f32 v159, v159, v159
    v_lshlrev_b32 v159, 16, v159
    v_mul_f32 v159, 0.25, v159
    v_cvt_pk_bf16_f32 v160, v160, v160
    v_lshlrev_b32 v160, 16, v160
    v_mul_f32 v160, 0.25, v160
    v_cvt_pk_bf16_f32 v161, v161, v161
    v_lshlrev_b32 v161, 16, v161
    v_mul_f32 v161, 0.25, v161
    v_cvt_pk_bf16_f32 v162, v162, v162
    v_lshlrev_b32 v162, 16, v162
    v_mul_f32 v162, 0.25, v162
    v_cvt_pk_bf16_f32 v163, v163, v163
    v_lshlrev_b32 v163, 16, v163
    v_mul_f32 v163, 0.25, v163
    v_mov_b32 v7, s33
    v_add_u32 v5, 0, v9
    v_cmp_lt_u32 vcc, v4, v5
    s_nop 1
    v_cndmask_b32 v96, v7, v96, vcc
    v_cmp_ge_u32 vcc, v4, v5
    s_nop 1
    v_cndmask_b32 v160, v7, v160, vcc
    v_add_u32 v5, 1, v9
    v_cmp_lt_u32 vcc, v4, v5
    s_nop 1
    v_cndmask_b32 v97, v7, v97, vcc
    v_cmp_ge_u32 vcc, v4, v5
    s_nop 1
    v_cndmask_b32 v161, v7, v161, vcc
    v_add_u32 v5, 2, v9
    v_cmp_lt_u32 vcc, v4, v5
    s_nop 1
    v_cndmask_b32 v98, v7, v98, vcc
    v_cmp_ge_u32 vcc, v4, v5
    s_nop 1
    v_cndmask_b32 v162, v7, v162, vcc
    v_add_u32 v5, 3, v9
    v_cmp_lt_u32 vcc, v4, v5
    s_nop 1
    v_cndmask_b32 v99, v7, v99, vcc
    v_cmp_ge_u32 vcc, v4, v5
    s_nop 1
    v_cndmask_b32 v163, v7, v163, vcc
    s_cmp_ge_u32 s28, 256
    s_cbranch_scc1 k2_attn_kernel_ok0
    v_mov_b32 v96, s33
    v_mov_b32 v97, s33
    v_mov_b32 v98, s33
    v_mov_b32 v99, s33
k2_attn_kernel_ok0:
    s_cmp_ge_u32 s28, 240
    s_cbranch_scc1 k2_attn_kernel_ok1
    v_mov_b32 v100, s33
    v_mov_b32 v101, s33
    v_mov_b32 v102, s33
    v_mov_b32 v103, s33
k2_attn_kernel_ok1:
    s_cmp_ge_u32 s28, 224
    s_cbranch_scc1 k2_attn_kernel_ok2
    v_mov_b32 v104, s33
    v_mov_b32 v105, s33
    v_mov_b32 v106, s33
    v_mov_b32 v107, s33
k2_attn_kernel_ok2:
    s_cmp_ge_u32 s28, 208
    s_cbranch_scc1 k2_attn_kernel_ok3
    v_mov_b32 v108, s33
    v_mov_b32 v109, s33
    v_mov_b32 v110, s33
    v_mov_b32 v111, s33
k2_attn_kernel_ok3:
    s_cmp_ge_u32 s28, 192
    s_cbranch_scc1 k2_attn_kernel_ok4
    v_mov_b32 v112, s33
    v_mov_b32 v113, s33
    v_mov_b32 v114, s33
    v_mov_b32 v115, s33
k2_attn_kernel_ok4:
    s_cmp_ge_u32 s28, 176
    s_cbranch_scc1 k2_attn_kernel_ok5
    v_mov_b32 v116, s33
    v_mov_b32 v117, s33
    v_mov_b32 v118, s33
    v_mov_b32 v119, s33
k2_attn_kernel_ok5:
    s_cmp_ge_u32 s28, 160
    s_cbranch_scc1 k2_attn_kernel_ok6
    v_mov_b32 v120, s33
    v_mov_b32 v121, s33
    v_mov_b32 v122, s33
    v_mov_b32 v123, s33
k2_attn_kernel_ok6:
    s_cmp_ge_u32 s28, 144
    s_cbranch_scc1 k2_attn_kernel_ok7
    v_mov_b32 v124, s33
    v_mov_b32 v125, s33
    v_mov_b32 v126, s33
    v_mov_b32 v127, s33
k2_attn_kernel_ok7:
    s_cmp_ge_u32 s28, 128
    s_cbranch_scc1 k2_attn_kernel_ok8
    v_mov_b32 v128, s33
    v_mov_b32 v129, s33
    v_mov_b32 v130, s33
    v_mov_b32 v131, s33
k2_attn_kernel_ok8:
    s_cmp_ge_u32 s28, 112
    s_cbranch_scc1 k2_attn_kernel_ok9
    v_mov_b32 v132, s33
    v_mov_b32 v133, s33
    v_mov_b32 v134, s33
    v_mov_b32 v135, s33
k2_attn_kernel_ok9:
    s_cmp_ge_u32 s28, 96
    s_cbranch_scc1 k2_attn_kernel_ok10
    v_mov_b32 v136, s33
    v_mov_b32 v137, s33
    v_mov_b32 v138, s33
    v_mov_b32 v139, s33
k2_attn_kernel_ok10:
    s_cmp_ge_u32 s28, 80
    s_cbranch_scc1 k2_attn_kernel_ok11
    v_mov_b32 v140, s33
    v_mov_b32 v141, s33
    v_mov_b32 v142, s33
    v_mov_b32 v143, s33
k2_attn_kernel_ok11:
    s_cmp_ge_u32 s28, 64
    s_cbranch_scc1 k2_attn_kernel_ok12
    v_mov_b32 v144, s33
    v_mov_b32 v145, s33
    v_mov_b32 v146, s33
    v_mov_b32 v147, s33
k2_attn_kernel_ok12:
    s_cmp_ge_u32 s28, 48
    s_cbranch_scc1 k2_attn_kernel_ok13
    v_mov_b32 v148, s33
    v_mov_b32 v149, s33
    v_mov_b32 v150, s33
    v_mov_b32 v151, s33
k2_attn_kernel_ok13:
    s_cmp_ge_u32 s28, 32
    s_cbranch_scc1 k2_attn_kernel_ok14
    v_mov_b32 v152, s33
    v_mov_b32 v153, s33
    v_mov_b32 v154, s33
    v_mov_b32 v155, s33
k2_attn_kernel_ok14:
    s_cmp_ge_u32 s28, 16
    s_cbranch_scc1 k2_attn_kernel_ok15
    v_mov_b32 v156, s33
    v_mov_b32 v157, s33
    v_mov_b32 v158, s33
    v_mov_b32 v159, s33
k2_attn_kernel_ok15:
    v_max3_f32 v5, v96, v97, v98
    v_max3_f32 v5, v5, v99, v100
    v_max3_f32 v5, v5, v101, v102
    v_max3_f32 v5, v5, v103, v104
    v_max3_f32 v5, v5, v105, v106
    v_max3_f32 v5, v5, v107, v108
    v_max3_f32 v5, v5, v109, v110
    v_max3_f32 v5, v5, v111, v112
    v_max3_f32 v5, v5, v113, v114
    v_max3_f32 v5, v5, v115, v116
    v_max3_f32 v5, v5, v117, v118
    v_max3_f32 v5, v5, v119, v120
    v_max3_f32 v5, v5, v121, v122
    v_max3_f32 v5, v5, v123, v124
    v_max3_f32 v5, v5, v125, v126
    v_max3_f32 v5, v5, v127, v128
    v_max3_f32 v5, v5, v129, v130
    v_max3_f32 v5, v5, v131, v132
    v_max3_f32 v5, v5, v133, v134
    v_max3_f32 v5, v5, v135, v136
    v_max3_f32 v5, v5, v137, v138
    v_max3_f32 v5, v5, v139, v140
    v_max3_f32 v5, v5, v141, v142
    v_max3_f32 v5, v5, v143, v144
    v_max3_f32 v5, v5, v145, v146
    v_max3_f32 v5, v5, v147, v148
    v_max3_f32 v5, v5, v149, v150
    v_max3_f32 v5, v5, v151, v152
    v_max3_f32 v5, v5, v153, v154
    v_max3_f32 v5, v5, v155, v156
    v_max3_f32 v5, v5, v157, v158
    v_max3_f32 v5, v5, v159, v160
    v_max3_f32 v5, v5, v161, v162
    v_max_f32 v5, v5, v163
    v_mov_b32 v6, v5
    s_nop 1
    v_permlane32_swap_b32 v6, v5
    v_max_f32 v5, v5, v6
    v_mov_b32 v6, v5
    s_nop 1
    v_permlane16_swap_b32 v6, v5
    v_max_f32 v5, v5, v6
    s_mov_b32 s34, 0x3fb8aa3b
    v_mul_f32 v5, s34, v5
    v_mov_b32 v8, 0
    v_fma_f32 v96, v96, s34, -v5
    v_exp_f32 v96, v96
    s_nop 0
    v_add_f32 v8, v8, v96
    v_fma_f32 v97, v97, s34, -v5
    v_exp_f32 v97, v97
    s_nop 0
    v_add_f32 v8, v8, v97
    v_fma_f32 v98, v98, s34, -v5
    v_exp_f32 v98, v98
    s_nop 0
    v_add_f32 v8, v8, v98
    v_fma_f32 v99, v99, s34, -v5
    v_exp_f32 v99, v99
    s_nop 0
    v_add_f32 v8, v8, v99
    v_fma_f32 v100, v100, s34, -v5
    v_exp_f32 v100, v100
    s_nop 0
    v_add_f32 v8, v8, v100
    v_fma_f32 v101, v101, s34, -v5
    v_exp_f32 v101, v101
    s_nop 0
    v_add_f32 v8, v8, v101
    v_fma_f32 v102, v102, s34, -v5
    v_exp_f32 v102, v102
    s_nop 0
    v_add_f32 v8, v8, v102
    v_fma_f32 v103, v103, s34, -v5
    v_exp_f32 v103, v103
    s_nop 0
    v_add_f32 v8, v8, v103
    v_fma_f32 v104, v104, s34, -v5
    v_exp_f32 v104, v104
    s_nop 0
    v_add_f32 v8, v8, v104
    v_fma_f32 v105, v105, s34, -v5
    v_exp_f32 v105, v105
    s_nop 0
    v_add_f32 v8, v8, v105
    v_fma_f32 v106, v106, s34, -v5
    v_exp_f32 v106, v106
    s_nop 0
    v_add_f32 v8, v8, v106
    v_fma_f32 v107, v107, s34, -v5
    v_exp_f32 v107, v107
    s_nop 0
    v_add_f32 v8, v8, v107
    v_fma_f32 v108, v108, s34, -v5
    v_exp_f32 v108, v108
    s_nop 0
    v_add_f32 v8, v8, v108
    v_fma_f32 v109, v109, s34, -v5
    v_exp_f32 v109, v109
    s_nop 0
    v_add_f32 v8, v8, v109
    v_fma_f32 v110, v110, s34, -v5
    v_exp_f32 v110, v110
    s_nop 0
    v_add_f32 v8, v8, v110
    v_fma_f32 v111, v111, s34, -v5
    v_exp_f32 v111, v111
    s_nop 0
    v_add_f32 v8, v8, v111
    v_fma_f32 v112, v112, s34, -v5
    v_exp_f32 v112, v112
    s_nop 0
    v_add_f32 v8, v8, v112
    v_fma_f32 v113, v113, s34, -v5
    v_exp_f32 v113, v113
    s_nop 0
    v_add_f32 v8, v8, v113
    v_fma_f32 v114, v114, s34, -v5
    v_exp_f32 v114, v114
    s_nop 0
    v_add_f32 v8, v8, v114
    v_fma_f32 v115, v115, s34, -v5
    v_exp_f32 v115, v115
    s_nop 0
    v_add_f32 v8, v8, v115
    v_fma_f32 v116, v116, s34, -v5
    v_exp_f32 v116, v116
    s_nop 0
    v_add_f32 v8, v8, v116
    v_fma_f32 v117, v117, s34, -v5
    v_exp_f32 v117, v117
    s_nop 0
    v_add_f32 v8, v8, v117
    v_fma_f32 v118, v118, s34, -v5
    v_exp_f32 v118, v118
    s_nop 0
    v_add_f32 v8, v8, v118
    v_fma_f32 v119, v119, s34, -v5
    v_exp_f32 v119, v119
    s_nop 0
    v_add_f32 v8, v8, v119
    v_fma_f32 v120, v120, s34, -v5
    v_exp_f32 v120, v120
    s_nop 0
    v_add_f32 v8, v8, v120
    v_fma_f32 v121, v121, s34, -v5
    v_exp_f32 v121, v121
    s_nop 0
    v_add_f32 v8, v8, v121
    v_fma_f32 v122, v122, s34, -v5
    v_exp_f32 v122, v122
    s_nop 0
    v_add_f32 v8, v8, v122
    v_fma_f32 v123, v123, s34, -v5
    v_exp_f32 v123, v123
    s_nop 0
    v_add_f32 v8, v8, v123
    v_fma_f32 v124, v124, s34, -v5
    v_exp_f32 v124, v124
    s_nop 0
    v_add_f32 v8, v8, v124
    v_fma_f32 v125, v125, s34, -v5
    v_exp_f32 v125, v125
    s_nop 0
    v_add_f32 v8, v8, v125
    v_fma_f32 v126, v126, s34, -v5
    v_exp_f32 v126, v126
    s_nop 0
    v_add_f32 v8, v8, v126
    v_fma_f32 v127, v127, s34, -v5
    v_exp_f32 v127, v127
    s_nop 0
    v_add_f32 v8, v8, v127
    v_fma_f32 v128, v128, s34, -v5
    v_exp_f32 v128, v128
    s_nop 0
    v_add_f32 v8, v8, v128
    v_fma_f32 v129, v129, s34, -v5
    v_exp_f32 v129, v129
    s_nop 0
    v_add_f32 v8, v8, v129
    v_fma_f32 v130, v130, s34, -v5
    v_exp_f32 v130, v130
    s_nop 0
    v_add_f32 v8, v8, v130
    v_fma_f32 v131, v131, s34, -v5
    v_exp_f32 v131, v131
    s_nop 0
    v_add_f32 v8, v8, v131
    v_fma_f32 v132, v132, s34, -v5
    v_exp_f32 v132, v132
    s_nop 0
    v_add_f32 v8, v8, v132
    v_fma_f32 v133, v133, s34, -v5
    v_exp_f32 v133, v133
    s_nop 0
    v_add_f32 v8, v8, v133
    v_fma_f32 v134, v134, s34, -v5
    v_exp_f32 v134, v134
    s_nop 0
    v_add_f32 v8, v8, v134
    v_fma_f32 v135, v135, s34, -v5
    v_exp_f32 v135, v135
    s_nop 0
    v_add_f32 v8, v8, v135
    v_fma_f32 v136, v136, s34, -v5
    v_exp_f32 v136, v136
    s_nop 0
    v_add_f32 v8, v8, v136
    v_fma_f32 v137, v137, s34, -v5
    v_exp_f32 v137, v137
    s_nop 0
    v_add_f32 v8, v8, v137
    v_fma_f32 v138, v138, s34, -v5
    v_exp_f32 v138, v138
    s_nop 0
    v_add_f32 v8, v8, v138
    v_fma_f32 v139, v139, s34, -v5
    v_exp_f32 v139, v139
    s_nop 0
    v_add_f32 v8, v8, v139
    v_fma_f32 v140, v140, s34, -v5
    v_exp_f32 v140, v140
    s_nop 0
    v_add_f32 v8, v8, v140
    v_fma_f32 v141, v141, s34, -v5
    v_exp_f32 v141, v141
    s_nop 0
    v_add_f32 v8, v8, v141
    v_fma_f32 v142, v142, s34, -v5
    v_exp_f32 v142, v142
    s_nop 0
    v_add_f32 v8, v8, v142
    v_fma_f32 v143, v143, s34, -v5
    v_exp_f32 v143, v143
    s_nop 0
    v_add_f32 v8, v8, v143
    v_fma_f32 v144, v144, s34, -v5
    v_exp_f32 v144, v144
    s_nop 0
    v_add_f32 v8, v8, v144
    v_fma_f32 v145, v145, s34, -v5
    v_exp_f32 v145, v145
    s_nop 0
    v_add_f32 v8, v8, v145
    v_fma_f32 v146, v146, s34, -v5
    v_exp_f32 v146, v146
    s_nop 0
    v_add_f32 v8, v8, v146
    v_fma_f32 v147, v147, s34, -v5
    v_exp_f32 v147, v147
    s_nop 0
    v_add_f32 v8, v8, v147
    v_fma_f32 v148, v148, s34, -v5
    v_exp_f32 v148, v148
    s_nop 0
    v_add_f32 v8, v8, v148
    v_fma_f32 v149, v149, s34, -v5
    v_exp_f32 v149, v149
    s_nop 0
    v_add_f32 v8, v8, v149
    v_fma_f32 v150, v150, s34, -v5
    v_exp_f32 v150, v150
    s_nop 0
    v_add_f32 v8, v8, v150
    v_fma_f32 v151, v151, s34, -v5
    v_exp_f32 v151, v151
    s_nop 0
    v_add_f32 v8, v8, v151
    v_fma_f32 v152, v152, s34, -v5
    v_exp_f32 v152, v152
    s_nop 0
    v_add_f32 v8, v8, v152
    v_fma_f32 v153, v153, s34, -v5
    v_exp_f32 v153, v153
    s_nop 0
    v_add_f32 v8, v8, v153
    v_fma_f32 v154, v154, s34, -v5
    v_exp_f32 v154, v154
    s_nop 0
    v_add_f32 v8, v8, v154
    v_fma_f32 v155, v155, s34, -v5
    v_exp_f32 v155, v155
    s_nop 0
    v_add_f32 v8, v8, v155
    v_fma_f32 v156, v156, s34, -v5
    v_exp_f32 v156, v156
    s_nop 0
    v_add_f32 v8, v8, v156
    v_fma_f32 v157, v157, s34, -v5
    v_exp_f32 v157, v157
    s_nop 0
    v_add_f32 v8, v8, v157
    v_fma_f32 v158, v158, s34, -v5
    v_exp_f32 v158, v158
    s_nop 0
    v_add_f32 v8, v8, v158
    v_fma_f32 v159, v159, s34, -v5
    v_exp_f32 v159, v159
    s_nop 0
    v_add_f32 v8, v8, v159
    v_fma_f32 v160, v160, s34, -v5
    v_exp_f32 v160, v160
    s_nop 0
    v_add_f32 v8, v8, v160
    v_fma_f32 v161, v161, s34, -v5
    v_exp_f32 v161, v161
    s_nop 0
    v_add_f32 v8, v8, v161
    v_fma_f32 v162, v162, s34, -v5
    v_exp_f32 v162, v162
    s_nop 0
    v_add_f32 v8, v8, v162
    v_fma_f32 v163, v163, s34, -v5
    v_exp_f32 v163, v163
    s_nop 0
    v_add_f32 v8, v8, v163
    v_mov_b32 v6, v8
    s_nop 1
    v_permlane32_swap_b32 v6, v8
    v_add_f32 v8, v8, v6
    v_mov_b32 v6, v8
    s_nop 1
    v_permlane16_swap_b32 v6, v8
    v_add_f32 v8, v8, v6
    v_rcp_f32 v8, v8
    s_nop 0
    v_mul_f32 v96, v96, v8
    v_mul_f32 v97, v97, v8
    v_mul_f32 v98, v98, v8
    v_mul_f32 v99, v99, v8
    v_mul_f32 v100, v100, v8
    v_mul_f32 v101, v101, v8
    v_mul_f32 v102, v102, v8
    v_mul_f32 v103, v103, v8
    v_mul_f32 v104, v104, v8
    v_mul_f32 v105, v105, v8
    v_mul_f32 v106, v106, v8
    v_mul_f32 v107, v107, v8
    v_mul_f32 v108, v108, v8
    v_mul_f32 v109, v109, v8
    v_mul_f32 v110, v110, v8
    v_mul_f32 v111, v111, v8
    v_mul_f32 v112, v112, v8
    v_mul_f32 v113, v113, v8
    v_mul_f32 v114, v114, v8
    v_mul_f32 v115, v115, v8
    v_mul_f32 v116, v116, v8
    v_mul_f32 v117, v117, v8
    v_mul_f32 v118, v118, v8
    v_mul_f32 v119, v119, v8
    v_mul_f32 v120, v120, v8
    v_mul_f32 v121, v121, v8
    v_mul_f32 v122, v122, v8
    v_mul_f32 v123, v123, v8
    v_mul_f32 v124, v124, v8
    v_mul_f32 v125, v125, v8
    v_mul_f32 v126, v126, v8
    v_mul_f32 v127, v127, v8
    v_mul_f32 v128, v128, v8
    v_mul_f32 v129, v129, v8
    v_mul_f32 v130, v130, v8
    v_mul_f32 v131, v131, v8
    v_mul_f32 v132, v132, v8
    v_mul_f32 v133, v133, v8
    v_mul_f32 v134, v134, v8
    v_mul_f32 v135, v135, v8
    v_mul_f32 v136, v136, v8
    v_mul_f32 v137, v137, v8
    v_mul_f32 v138, v138, v8
    v_mul_f32 v139, v139, v8
    v_mul_f32 v140, v140, v8
    v_mul_f32 v141, v141, v8
    v_mul_f32 v142, v142, v8
    v_mul_f32 v143, v143, v8
    v_mul_f32 v144, v144, v8
    v_mul_f32 v145, v145, v8
    v_mul_f32 v146, v146, v8
    v_mul_f32 v147, v147, v8
    v_mul_f32 v148, v148, v8
    v_mul_f32 v149, v149, v8
    v_mul_f32 v150, v150, v8
    v_mul_f32 v151, v151, v8
    v_mul_f32 v152, v152, v8
    v_mul_f32 v153, v153, v8
    v_mul_f32 v154, v154, v8
    v_mul_f32 v155, v155, v8
    v_mul_f32 v156, v156, v8
    v_mul_f32 v157, v157, v8
    v_mul_f32 v158, v158, v8
    v_mul_f32 v159, v159, v8
    v_mul_f32 v160, v160, v8
    v_mul_f32 v161, v161, v8
    v_mul_f32 v162, v162, v8
    v_mul_f32 v163, v163, v8
    v_cvt_pk_bf16_f32 v96, v96, v97
    v_cvt_pk_bf16_f32 v97, v98, v99
    v_cvt_pk_bf16_f32 v98, v100, v101
    v_cvt_pk_bf16_f32 v99, v102, v103
    v_cvt_pk_bf16_f32 v100, v104, v105
    v_cvt_pk_bf16_f32 v101, v106, v107
    v_cvt_pk_bf16_f32 v102, v108, v109
    v_cvt_pk_bf16_f32 v103, v110, v111
    v_cvt_pk_bf16_f32 v104, v112, v113
    v_cvt_pk_bf16_f32 v105, v114, v115
    v_cvt_pk_bf16_f32 v106, v116, v117
    v_cvt_pk_bf16_f32 v107, v118, v119
    v_cvt_pk_bf16_f32 v108, v120, v121
    v_cvt_pk_bf16_f32 v109, v122, v123
    v_cvt_pk_bf16_f32 v110, v124, v125
    v_cvt_pk_bf16_f32 v111, v126, v127
    v_cvt_pk_bf16_f32 v112, v128, v129
    v_cvt_pk_bf16_f32 v113, v130, v131
    v_cvt_pk_bf16_f32 v114, v132, v133
    v_cvt_pk_bf16_f32 v115, v134, v135
    v_cvt_pk_bf16_f32 v116, v136, v137
    v_cvt_pk_bf16_f32 v117, v138, v139
    v_cvt_pk_bf16_f32 v118, v140, v141
    v_cvt_pk_bf16_f32 v119, v142, v143
    v_cvt_pk_bf16_f32 v120, v144, v145
    v_cvt_pk_bf16_f32 v121, v146, v147
    v_cvt_pk_bf16_f32 v122, v148, v149
    v_cvt_pk_bf16_f32 v123, v150, v151
    v_cvt_pk_bf16_f32 v124, v152, v153
    v_cvt_pk_bf16_f32 v125, v154, v155
    v_cvt_pk_bf16_f32 v126, v156, v157
    v_cvt_pk_bf16_f32 v127, v158, v159
    v_cvt_pk_bf16_f32 v128, v160, v161
    v_cvt_pk_bf16_f32 v129, v162, v163
    v_mov_b32 v130, 0
    v_mov_b32 v131, 0
    s_waitcnt vmcnt(0)
    v_mfma_f32_16x16x32_bf16 v[12:15], v[52:55], v[96:99], v[12:15]
    v_mfma_f32_16x16x32_bf16 v[12:15], v[56:59], v[100:103], v[12:15]
    v_mfma_f32_16x16x32_bf16 v[12:15], v[60:63], v[104:107], v[12:15]
    v_mfma_f32_16x16x32_bf16 v[12:15], v[64:67], v[108:111], v[12:15]
    v_mfma_f32_16x16x32_bf16 v[12:15], v[68:71], v[112:115], v[12:15]
    v_mfma_f32_16x16x32_bf16 v[12:15], v[72:75], v[116:119], v[12:15]
    v_mfma_f32_16x16x32_bf16 v[12:15], v[76:79], v[120:123], v[12:15]
    v_mfma_f32_16x16x32_bf16 v[12:15], v[80:83], v[124:127], v[12:15]
    v_mfma_f32_16x16x32_bf16 v[12:15], v[84:87], v[128:131], v[12:15]
    s_nop 7
    s_nop 6
    v_cvt_pk_bf16_f32 v12, v12, v13
    v_cvt_pk_bf16_f32 v13, v14, v15
    v_add_u32 v5, s28, v4
    v_lshlrev_b32 v5, 10, v5
    v_lshl_add_u32 v5, v3, 3, v5
    s_lshl_b32 s31, s29, 5
    v_add_u32 v5, s31, v5
    buffer_store_dwordx2 v[12:13], v5, s[20:23], 0 offen
k2_attn_kernel_end:
    s_endpgm
.p2align 8
.globl k3_wo_kernel
.type k3_wo_kernel,@function
k3_wo_kernel:
    s_cmp_ge_u32 s2, 256
    s_cbranch_scc1 k3_wo_kernel_end
    s_load_dwordx2 s[8:9], s[0:1], 80
    s_load_dwordx2 s[6:7], s[0:1], 16
    s_load_dwordx2 s[4:5], s[0:1], 0
    s_mul_i32 s28, s2, 8193
    s_lshr_b32 s28, s28, 16
    s_mul_i32 s29, s28, 8
    s_sub_u32 s29, s2, s29
    s_lshl_b32 s28, s28, 6
    s_mul_i32 s29, s29, 64
    v_and_b32 v1, 63, v0
    v_lshrrev_b32 v2, 6, v0
    s_nop 0
    v_readfirstlane_b32 s30, v2
    s_waitcnt lgkmcnt(0)
    s_add_u32 s12, s8, 0x600000
    s_addc_u32 s13, s9, 0
    s_and_b32 s13, s13, 0xffff
    s_mov_b32 s14, 0x200000
    s_mov_b32 s15, 0x00020000
    s_mov_b32 s16, s6
    s_and_b32 s17, s7, 0xffff
    s_mov_b32 s18, 0x80000
    s_mov_b32 s19, 0x00020000
    s_mov_b32 s20, s4
    s_and_b32 s21, s5, 0xffff
    s_mov_b32 s22, 0x200000
    s_mov_b32 s23, 0x00020000
    s_add_u32 s24, s8, 0x800000
    s_addc_u32 s25, s9, 0
    s_and_b32 s25, s25, 0xffff
    s_mov_b32 s26, 0x200000
    s_mov_b32 s27, 0x00020000
    s_mov_b32 s34, 1024
    s_mov_b32 s35, 1024
    v_add_u32 v3, 0, v0
    v_lshrrev_b32 v4, 3, v3
    v_and_b32 v5, 7, v3
    v_add_u32 v6, s28, v4
    v_mul_u32_u24 v6, s34, v6
    v_lshl_add_u32 v8, v5, 4, v6
    v_and_b32 v6, 7, v4
    v_xor_b32 v6, v6, v5
    v_lshlrev_b32 v6, 4, v6
    v_lshl_add_u32 v10, v4, 7, v6
    v_add_u32 v3, 0, v0
    v_lshrrev_b32 v4, 3, v3
    v_and_b32 v5, 7, v3
    v_mul_u32_u24 v6, s35, v4
    s_lshl_b32 s36, s29, 1
    v_lshl_add_u32 v6, v5, 4, v6
    v_add_u32 v12, s36, v6
    v_bfe_u32 v6, v4, 2, 1
    v_bfe_u32 v7, v4, 3, 1
    v_and_b32 v4, 0xfffffff3, v4
    v_lshl_or_b32 v4, v6, 3, v4
    v_lshl_or_b32 v4, v7, 2, v4
    s_mov_b32 s37, 160
    v_mul_u32_u24 v6, s37, v4
    v_lshl_add_u32 v6, v5, 4, v6
    v_add_u32 v16, 8192, v6
    s_mov_b32 s48, 0
    s_mov_b32 s49, 0
    buffer_load_dwordx4 v[64:67], v8, s[12:15], s48 offen
    buffer_load_dwordx4 v[68:71], v12, s[16:19], s49 offen
    s_add_u32 s48, s48, 128
    s_add_u32 s49, s49, 65536
    buffer_load_dwordx4 v[72:75], v8, s[12:15], s48 offen
    buffer_load_dwordx4 v[76:79], v12, s[16:19], s49 offen
    s_add_u32 s48, s48, 128
    s_add_u32 s49, s49, 65536
    buffer_load_dwordx4 v[80:83], v8, s[12:15], s48 offen
    buffer_load_dwordx4 v[84:87], v12, s[16:19], s49 offen
    s_add_u32 s48, s48, 128
    s_add_u32 s49, s49, 65536
    buffer_load_dwordx4 v[88:91], v8, s[12:15], s48 offen
    buffer_load_dwordx4 v[92:95], v12, s[16:19], s49 offen
    s_add_u32 s48, s48, 128
    s_add_u32 s49, s49, 65536
    v_lshrrev_b32 v3, 4, v1
    v_and_b32 v4, 15, v1
    s_lshr_b32 s37, s30, 1
    s_lshl_b32 s37, s37, 11
    v_and_b32 v6, 7, v4
    v_lshlrev_b32 v5, 7, v4
    v_add_u32 v5, s37, v5
    v_add_u32 v20, 0, v3
    v_xor_b32 v20, v20, v6
    v_lshl_add_u32 v20, v20, 4, v5
    v_add_u32 v21, 4, v3
    v_xor_b32 v21, v21, v6
    v_lshl_add_u32 v21, v21, 4, v5
    v_lshrrev_b32 v5, 1, v3
    v_lshlrev_b32 v5, 4, v5
    v_and_b32 v6, 1, v3
    v_lshl_add_u32 v5, v6, 2, v5
    v_lshrrev_b32 v6, 2, v4
    v_add_u32 v5, v5, v6
    s_mov_b32 s37, 160
    v_mul_u32_u24 v5, s37, v5
    v_and_b32 v6, 3, v4
    v_lshl_add_u32 v5, v6, 3, v5
    s_and_b32 s38, s30, 1
    s_mul_i32 s38, s38, 64
    s_add_u32 s38, s38, 8192
    v_add_u32 v22, s38, v5
    v_mov_b32 v192, 0
    v_mov_b32 v193, 0
    v_mov_b32 v194, 0
    v_mov_b32 v195, 0
    v_mov_b32 v196, 0
    v_mov_b32 v197, 0
    v_mov_b32 v198, 0
    v_mov_b32 v199, 0
    s_waitcnt vmcnt(6)
    ds_write_b128 v10, v[64:67] offset:0
    ds_write_b128 v16, v[68:71] offset:0
    buffer_load_dwordx4 v[64:67], v8, s[12:15], s48 offen
    buffer_load_dwordx4 v[68:71], v12, s[16:19], s49 offen
    s_add_u32 s48, s48, 128
    s_add_u32 s49, s49, 65536
    s_waitcnt lgkmcnt(0)
    s_barrier
    s_mov_b32 s50, 1
k3_wo_kernel_loop:
    ds_read_b128 v[24:27], v20 offset:0
    ds_read_b64_tr_b16 v[32:33], v22 offset:0
    ds_read_b64_tr_b16 v[34:35], v22 offset:1280
    ds_read_b64_tr_b16 v[36:37], v22 offset:32
    ds_read_b64_tr_b16 v[38:39], v22 offset:1312
    s_waitcnt lgkmcnt(2)
    v_mfma_f32_16x16x32_bf16 v[192:195], v[32:35], v[24:27], v[192:195]
    s_waitcnt lgkmcnt(0)
    v_mfma_f32_16x16x32_bf16 v[196:199], v[36:39], v[24:27], v[196:199]
    ds_read_b128 v[24:27], v21 offset:0
    ds_read_b64_tr_b16 v[32:33], v22 offset:5120
    ds_read_b64_tr_b16 v[34:35], v22 offset:6400
    ds_read_b64_tr_b16 v[36:37], v22 offset:5152
    ds_read_b64_tr_b16 v[38:39], v22 offset:6432
    s_waitcnt lgkmcnt(2)
    v_mfma_f32_16x16x32_bf16 v[192:195], v[32:35], v[24:27], v[192:195]
    s_waitcnt lgkmcnt(0)
    v_mfma_f32_16x16x32_bf16 v[196:199], v[36:39], v[24:27], v[196:199]
    s_waitcnt vmcnt(6)
    ds_write_b128 v10, v[72:75] offset:18432
    ds_write_b128 v16, v[76:79] offset:18432
    buffer_load_dwordx4 v[72:75], v8, s[12:15], s48 offen
    buffer_load_dwordx4 v[76:79], v12, s[16:19], s49 offen
    s_add_u32 s48, s48, 128
    s_add_u32 s49, s49, 65536
    s_waitcnt lgkmcnt(0)
    s_barrier
    ds_read_b128 v[24:27], v20 offset:18432
    ds_read_b64_tr_b16 v[32:33], v22 offset:18432
    ds_read_b64_tr_b16 v[34:35], v22 offset:19712
    ds_read_b64_tr_b16 v[36:37], v22 offset:18464
    ds_read_b64_tr_b16 v[38:39], v22 offset:19744
    s_waitcnt lgkmcnt(2)
    v_mfma_f32_16x16x32_bf16 v[192:195], v[32:35], v[24:27], v[192:195]
    s_waitcnt lgkmcnt(0)
    v_mfma_f32_16x16x32_bf16 v[196:199], v[36:39], v[24:27], v[196:199]
    ds_read_b128 v[24:27], v21 offset:18432
    ds_read_b64_tr_b16 v[32:33], v22 offset:23552
    ds_read_b64_tr_b16 v[34:35], v22 offset:24832
    ds_read_b64_tr_b16 v[36:37], v22 offset:23584
    ds_read_b64_tr_b16 v[38:39], v22 offset:24864
    s_waitcnt lgkmcnt(2)
    v_mfma_f32_16x16x32_bf16 v[192:195], v[32:35], v[24:27], v[192:195]
    s_waitcnt lgkmcnt(0)
    v_mfma_f32_16x16x32_bf16 v[196:199], v[36:39], v[24:27], v[196:199]
    s_waitcnt vmcnt(6)
    ds_write_b128 v10, v[80:83] offset:0
    ds_write_b128 v16, v[84:87] offset:0
    buffer_load_dwordx4 v[80:83], v8, s[12:15], s48 offen
    buffer_load_dwordx4 v[84:87], v12, s[16:19], s49 offen
    s_add_u32 s48, s48, 128
    s_add_u32 s49, s49, 65536
    s_waitcnt lgkmcnt(0)
    s_barrier
    ds_read_b128 v[24:27], v20 offset:0
    ds_read_b64_tr_b16 v[32:33], v22 offset:0
    ds_read_b64_tr_b16 v[34:35], v22 offset:1280
    ds_read_b64_tr_b16 v[36:37], v22 offset:32
    ds_read_b64_tr_b16 v[38:39], v22 offset:1312
    s_waitcnt lgkmcnt(2)
    v_mfma_f32_16x16x32_bf16 v[192:195], v[32:35], v[24:27], v[192:195]
    s_waitcnt lgkmcnt(0)
    v_mfma_f32_16x16x32_bf16 v[196:199], v[36:39], v[24:27], v[196:199]
    ds_read_b128 v[24:27], v21 offset:0
    ds_read_b64_tr_b16 v[32:33], v22 offset:5120
    ds_read_b64_tr_b16 v[34:35], v22 offset:6400
    ds_read_b64_tr_b16 v[36:37], v22 offset:5152
    ds_read_b64_tr_b16 v[38:39], v22 offset:6432
    s_waitcnt lgkmcnt(2)
    v_mfma_f32_16x16x32_bf16 v[192:195], v[32:35], v[24:27], v[192:195]
    s_waitcnt lgkmcnt(0)
    v_mfma_f32_16x16x32_bf16 v[196:199], v[36:39], v[24:27], v[196:199]
    s_waitcnt vmcnt(6)
    ds_write_b128 v10, v[88:91] offset:18432
    ds_write_b128 v16, v[92:95] offset:18432
    buffer_load_dwordx4 v[88:91], v8, s[12:15], s48 offen
    buffer_load_dwordx4 v[92:95], v12, s[16:19], s49 offen
    s_add_u32 s48, s48, 128
    s_add_u32 s49, s49, 65536
    s_waitcnt lgkmcnt(0)
    s_barrier
    ds_read_b128 v[24:27], v20 offset:18432
    ds_read_b64_tr_b16 v[32:33], v22 offset:18432
    ds_read_b64_tr_b16 v[34:35], v22 offset:19712
    ds_read_b64_tr_b16 v[36:37], v22 offset:18464
    ds_read_b64_tr_b16 v[38:39], v22 offset:19744
    s_waitcnt lgkmcnt(2)
    v_mfma_f32_16x16x32_bf16 v[192:195], v[32:35], v[24:27], v[192:195]
    s_waitcnt lgkmcnt(0)
    v_mfma_f32_16x16x32_bf16 v[196:199], v[36:39], v[24:27], v[196:199]
    ds_read_b128 v[24:27], v21 offset:18432
    ds_read_b64_tr_b16 v[32:33], v22 offset:23552
    ds_read_b64_tr_b16 v[34:35], v22 offset:24832
    ds_read_b64_tr_b16 v[36:37], v22 offset:23584
    ds_read_b64_tr_b16 v[38:39], v22 offset:24864
    s_waitcnt lgkmcnt(2)
    v_mfma_f32_16x16x32_bf16 v[192:195], v[32:35], v[24:27], v[192:195]
    s_waitcnt lgkmcnt(0)
    v_mfma_f32_16x16x32_bf16 v[196:199], v[36:39], v[24:27], v[196:199]
    s_waitcnt vmcnt(6)
    ds_write_b128 v10, v[64:67] offset:0
    ds_write_b128 v16, v[68:71] offset:0
    buffer_load_dwordx4 v[64:67], v8, s[12:15], s48 offen
    buffer_load_dwordx4 v[68:71], v12, s[16:19], s49 offen
    s_add_u32 s48, s48, 128
    s_add_u32 s49, s49, 65536
    s_waitcnt lgkmcnt(0)
    s_barrier
    ds_read_b128 v[24:27], v20 offset:0
    ds_read_b64_tr_b16 v[32:33], v22 offset:0
    ds_read_b64_tr_b16 v[34:35], v22 offset:1280
    ds_read_b64_tr_b16 v[36:37], v22 offset:32
    ds_read_b64_tr_b16 v[38:39], v22 offset:1312
    s_waitcnt lgkmcnt(2)
    v_mfma_f32_16x16x32_bf16 v[192:195], v[32:35], v[24:27], v[192:195]
    s_waitcnt lgkmcnt(0)
    v_mfma_f32_16x16x32_bf16 v[196:199], v[36:39], v[24:27], v[196:199]
    ds_read_b128 v[24:27], v21 offset:0
    ds_read_b64_tr_b16 v[32:33], v22 offset:5120
    ds_read_b64_tr_b16 v[34:35], v22 offset:6400
    ds_read_b64_tr_b16 v[36:37], v22 offset:5152
    ds_read_b64_tr_b16 v[38:39], v22 offset:6432
    s_waitcnt lgkmcnt(2)
    v_mfma_f32_16x16x32_bf16 v[192:195], v[32:35], v[24:27], v[192:195]
    s_waitcnt lgkmcnt(0)
    v_mfma_f32_16x16x32_bf16 v[196:199], v[36:39], v[24:27], v[196:199]
    s_waitcnt vmcnt(6)
    ds_write_b128 v10, v[72:75] offset:18432
    ds_write_b128 v16, v[76:79] offset:18432
    buffer_load_dwordx4 v[72:75], v8, s[12:15], s48 offen
    buffer_load_dwordx4 v[76:79], v12, s[16:19], s49 offen
    s_add_u32 s48, s48, 128
    s_add_u32 s49, s49, 65536
    s_waitcnt lgkmcnt(0)
    s_barrier
    ds_read_b128 v[24:27], v20 offset:18432
    ds_read_b64_tr_b16 v[32:33], v22 offset:18432
    ds_read_b64_tr_b16 v[34:35], v22 offset:19712
    ds_read_b64_tr_b16 v[36:37], v22 offset:18464
    ds_read_b64_tr_b16 v[38:39], v22 offset:19744
    s_waitcnt lgkmcnt(2)
    v_mfma_f32_16x16x32_bf16 v[192:195], v[32:35], v[24:27], v[192:195]
    s_waitcnt lgkmcnt(0)
    v_mfma_f32_16x16x32_bf16 v[196:199], v[36:39], v[24:27], v[196:199]
    ds_read_b128 v[24:27], v21 offset:18432
    ds_read_b64_tr_b16 v[32:33], v22 offset:23552
    ds_read_b64_tr_b16 v[34:35], v22 offset:24832
    ds_read_b64_tr_b16 v[36:37], v22 offset:23584
    ds_read_b64_tr_b16 v[38:39], v22 offset:24864
    s_waitcnt lgkmcnt(2)
    v_mfma_f32_16x16x32_bf16 v[192:195], v[32:35], v[24:27], v[192:195]
    s_waitcnt lgkmcnt(0)
    v_mfma_f32_16x16x32_bf16 v[196:199], v[36:39], v[24:27], v[196:199]
    s_waitcnt vmcnt(6)
    ds_write_b128 v10, v[80:83] offset:0
    ds_write_b128 v16, v[84:87] offset:0
    buffer_load_dwordx4 v[80:83], v8, s[12:15], s48 offen
    buffer_load_dwordx4 v[84:87], v12, s[16:19], s49 offen
    s_add_u32 s48, s48, 128
    s_add_u32 s49, s49, 65536
    s_waitcnt lgkmcnt(0)
    s_barrier
    ds_read_b128 v[24:27], v20 offset:0
    ds_read_b64_tr_b16 v[32:33], v22 offset:0
    ds_read_b64_tr_b16 v[34:35], v22 offset:1280
    ds_read_b64_tr_b16 v[36:37], v22 offset:32
    ds_read_b64_tr_b16 v[38:39], v22 offset:1312
    s_waitcnt lgkmcnt(2)
    v_mfma_f32_16x16x32_bf16 v[192:195], v[32:35], v[24:27], v[192:195]
    s_waitcnt lgkmcnt(0)
    v_mfma_f32_16x16x32_bf16 v[196:199], v[36:39], v[24:27], v[196:199]
    ds_read_b128 v[24:27], v21 offset:0
    ds_read_b64_tr_b16 v[32:33], v22 offset:5120
    ds_read_b64_tr_b16 v[34:35], v22 offset:6400
    ds_read_b64_tr_b16 v[36:37], v22 offset:5152
    ds_read_b64_tr_b16 v[38:39], v22 offset:6432
    s_waitcnt lgkmcnt(2)
    v_mfma_f32_16x16x32_bf16 v[192:195], v[32:35], v[24:27], v[192:195]
    s_waitcnt lgkmcnt(0)
    v_mfma_f32_16x16x32_bf16 v[196:199], v[36:39], v[24:27], v[196:199]
    s_waitcnt vmcnt(6)
    ds_write_b128 v10, v[88:91] offset:18432
    ds_write_b128 v16, v[92:95] offset:18432
    buffer_load_dwordx4 v[88:91], v8, s[12:15], s48 offen
    buffer_load_dwordx4 v[92:95], v12, s[16:19], s49 offen
    s_add_u32 s48, s48, 128
    s_add_u32 s49, s49, 65536
    s_waitcnt lgkmcnt(0)
    s_barrier
    ds_read_b128 v[24:27], v20 offset:18432
    ds_read_b64_tr_b16 v[32:33], v22 offset:18432
    ds_read_b64_tr_b16 v[34:35], v22 offset:19712
    ds_read_b64_tr_b16 v[36:37], v22 offset:18464
    ds_read_b64_tr_b16 v[38:39], v22 offset:19744
    s_waitcnt lgkmcnt(2)
    v_mfma_f32_16x16x32_bf16 v[192:195], v[32:35], v[24:27], v[192:195]
    s_waitcnt lgkmcnt(0)
    v_mfma_f32_16x16x32_bf16 v[196:199], v[36:39], v[24:27], v[196:199]
    ds_read_b128 v[24:27], v21 offset:18432
    ds_read_b64_tr_b16 v[32:33], v22 offset:23552
    ds_read_b64_tr_b16 v[34:35], v22 offset:24832
    ds_read_b64_tr_b16 v[36:37], v22 offset:23584
    ds_read_b64_tr_b16 v[38:39], v22 offset:24864
    s_waitcnt lgkmcnt(2)
    v_mfma_f32_16x16x32_bf16 v[192:195], v[32:35], v[24:27], v[192:195]
    s_waitcnt lgkmcnt(0)
    v_mfma_f32_16x16x32_bf16 v[196:199], v[36:39], v[24:27], v[196:199]
    s_waitcnt vmcnt(6)
    ds_write_b128 v10, v[64:67] offset:0
    ds_write_b128 v16, v[68:71] offset:0
    buffer_load_dwordx4 v[64:67], v8, s[12:15], s48 offen
    buffer_load_dwordx4 v[68:71], v12, s[16:19], s49 offen
    s_add_u32 s48, s48, 128
    s_add_u32 s49, s49, 65536
    s_waitcnt lgkmcnt(0)
    s_barrier
    s_nop 7
    s_lshr_b32 s37, s30, 1
    s_lshl_b32 s37, s37, 4
    s_add_u32 s37, s37, s28
    s_and_b32 s38, s30, 1
    s_mul_i32 s38, s38, 32
    s_add_u32 s38, s38, s29
    v_add_u32 v7, s37, v4
    s_mov_b32 s34, 1024
    v_mul_u32_u24 v5, s34, v7
    v_lshl_add_u32 v6, v3, 2, s38
    v_lshl_add_u32 v5, v6, 1, v5
    s_mov_b32 s42, 0
    s_mov_b32 s43, 16384
    s_waitcnt vmcnt(0)
    buffer_load_dwordx2 v[64:65], v5, s[20:23], s42 offen offset:0
    buffer_load_dwordx2 v[66:67], v5, s[20:23], s42 offen offset:32
    s_waitcnt vmcnt(0)
    v_cvt_pk_bf16_f32 v192, v192, v193
    v_cvt_pk_bf16_f32 v194, v194, v195
    v_and_b32 v193, 0xffff0000, v192
    v_lshlrev_b32 v192, 16, v192
    v_and_b32 v25, 0xffff0000, v64
    v_lshlrev_b32 v24, 16, v64
    v_add_f32 v192, v192, v24
    v_add_f32 v193, v193, v25
    v_cvt_pk_bf16_f32 v64, v192, v193
    v_and_b32 v195, 0xffff0000, v194
    v_lshlrev_b32 v194, 16, v194
    v_and_b32 v25, 0xffff0000, v65
    v_lshlrev_b32 v24, 16, v65
    v_add_f32 v194, v194, v24
    v_add_f32 v195, v195, v25
    v_cvt_pk_bf16_f32 v65, v194, v195
    buffer_store_dwordx2 v[64:65], v5, s[24:27], s42 offen offset:0
    v_cvt_pk_bf16_f32 v196, v196, v197
    v_cvt_pk_bf16_f32 v198, v198, v199
    v_and_b32 v197, 0xffff0000, v196
    v_lshlrev_b32 v196, 16, v196
    v_and_b32 v25, 0xffff0000, v66
    v_lshlrev_b32 v24, 16, v66
    v_add_f32 v196, v196, v24
    v_add_f32 v197, v197, v25
    v_cvt_pk_bf16_f32 v66, v196, v197
    v_and_b32 v199, 0xffff0000, v198
    v_lshlrev_b32 v198, 16, v198
    v_and_b32 v25, 0xffff0000, v67
    v_lshlrev_b32 v24, 16, v67
    v_add_f32 v198, v198, v24
    v_add_f32 v199, v199, v25
    v_cvt_pk_bf16_f32 v67, v198, v199
    buffer_store_dwordx2 v[66:67], v5, s[24:27], s42 offen offset:32
k3_wo_kernel_end:
    s_endpgm
.p2align 8
.globl k4_win_kernel
.type k4_win_kernel,@function
k4_win_kernel:
    s_cmp_ge_u32 s2, 256
    s_cbranch_scc1 k4_win_kernel_end
    s_load_dwordx2 s[4:5], s[0:1], 0
    s_load_dwordx2 s[6:7], s[0:1], 32
    s_load_dwordx2 s[8:9], s[0:1], 80
    s_lshr_b32 s28, s2, 3
    s_lshl_b32 s28, s28, 6
    s_and_b32 s29, s2, 7
    s_mul_i32 s29, s29, 224
    v_and_b32 v1, 63, v0
    v_lshrrev_b32 v2, 6, v0
    s_nop 0
    v_readfirstlane_b32 s30, v2
    s_waitcnt lgkmcnt(0)
    s_add_u32 s12, s8, 0x800000
    s_addc_u32 s13, s9, 0
    s_and_b32 s13, s13, 0xffff
    s_mov_b32 s14, 0x200000
    s_mov_b32 s15, 0x00020000
    s_add_u32 s20, s8, 0xa00000
    s_addc_u32 s21, s9, 0
    s_and_b32 s21, s21, 0xffff
    s_mov_b32 s22, 0x380000
    s_mov_b32 s23, 0x00020000
    s_add_u32 s24, s8, 0xe00000
    s_addc_u32 s25, s9, 0
    s_and_b32 s25, s25, 0xffff
    s_mov_b32 s26, 0x380000
    s_mov_b32 s27, 0x00020000
    s_mov_b32 s16, s6
    s_and_b32 s17, s7, 0xffff
    s_mov_b32 s18, 0x1c0000
    s_mov_b32 s19, 0x00020000
    s_mov_b32 s48, 256
    s_mov_b32 s32, 2341
    s_lshl_b32 s33, s29, 1
    v_add_u32 v3, 0, v0
    v_mul_u32_u24 v4, s32, v3
    v_lshrrev_b32 v4, 16, v4
    v_mul_u32_u24 v5, 28, v4
    v_sub_u32 v5, v3, v5
    v_lshlrev_b32 v5, 4, v5
    s_mov_b32 s34, 3584
    v_mul_u32_u24 v8, s34, v4
    v_add3_u32 v8, v8, v5, s33
    v_bfe_u32 v6, v4, 2, 1
    v_bfe_u32 v7, v4, 3, 1
    v_and_b32 v4, 0xfffffff3, v4
    v_lshl_or_b32 v4, v6, 3, v4
    v_lshl_or_b32 v4, v7, 2, v4
    s_mov_b32 s34, 480
    v_mul_u32_u24 v16, s34, v4
    v_add_u32 v16, v16, v5
    v_add_u32 v16, 65536, v16
    v_add_u32 v3, 512, v0
    v_mul_u32_u24 v4, s32, v3
    v_lshrrev_b32 v4, 16, v4
    v_mul_u32_u24 v5, 28, v4
    v_sub_u32 v5, v3, v5
    v_lshlrev_b32 v5, 4, v5
    s_mov_b32 s34, 3584
    v_mul_u32_u24 v9, s34, v4
    v_add3_u32 v9, v9, v5, s33
    v_bfe_u32 v6, v4, 2, 1
    v_bfe_u32 v7, v4, 3, 1
    v_and_b32 v4, 0xfffffff3, v4
    v_lshl_or_b32 v4, v6, 3, v4
    v_lshl_or_b32 v4, v7, 2, v4
    s_mov_b32 s34, 480
    v_mul_u32_u24 v17, s34, v4
    v_add_u32 v17, v17, v5
    v_add_u32 v17, 65536, v17
    v_add_u32 v3, 1024, v0
    v_mul_u32_u24 v4, s32, v3
    v_lshrrev_b32 v4, 16, v4
    v_mul_u32_u24 v5, 28, v4
    v_sub_u32 v5, v3, v5
    v_lshlrev_b32 v5, 4, v5
    s_mov_b32 s34, 3584
    v_mul_u32_u24 v10, s34, v4
    v_add3_u32 v10, v10, v5, s33
    v_bfe_u32 v6, v4, 2, 1
    v_bfe_u32 v7, v4, 3, 1
    v_and_b32 v4, 0xfffffff3, v4
    v_lshl_or_b32 v4, v6, 3, v4
    v_lshl_or_b32 v4, v7, 2, v4
    s_mov_b32 s34, 480
    v_mul_u32_u24 v18, s34, v4
    v_add_u32 v18, v18, v5
    v_add_u32 v18, 65536, v18
    v_add_u32 v3, 1536, v0
    v_mul_u32_u24 v4, s32, v3
    v_lshrrev_b32 v4, 16, v4
    v_mul_u32_u24 v5, 28, v4
    v_sub_u32 v5, v3, v5
    v_lshlrev_b32 v5, 4, v5
    s_mov_b32 s34, 3584
    v_mul_u32_u24 v11, s34, v4
    v_add3_u32 v11, v11, v5, s33
    v_bfe_u32 v6, v4, 2, 1
    v_bfe_u32 v7, v4, 3, 1
    v_and_b32 v4, 0xfffffff3, v4
    v_lshl_or_b32 v4, v6, 3, v4
    v_lshl_or_b32 v4, v7, 2, v4
    s_mov_b32 s34, 480
    v_mul_u32_u24 v19, s34, v4
    v_add_u32 v19, v19, v5
    v_add_u32 v19, 65536, v19
    v_cmp_gt_u32 s[46:47], s48, v0
    s_mov_b32 s35, 0
    buffer_load_dwordx4 v[184:187], v8, s[16:19], s35 offen
    buffer_load_dwordx4 v[188:191], v9, s[16:19], s35 offen
    buffer_load_dwordx4 v[192:195], v10, s[16:19], s35 offen
    buffer_load_dwordx4 v[196:199], v11, s[16:19], s35 offen
    s_mov_b32 s35, 229376
    buffer_load_dwordx4 v[212:215], v8, s[16:19], s35 offen
    buffer_load_dwordx4 v[216:219], v9, s[16:19], s35 offen
    buffer_load_dwordx4 v[220:223], v10, s[16:19], s35 offen
    buffer_load_dwordx4 v[224:227], v11, s[16:19], s35 offen
    v_lshrrev_b32 v3, 3, v0
    v_and_b32 v4, 7, v0
    v_add_u32 v5, s28, v3
    v_lshlrev_b32 v5, 10, v5
    v_lshl_add_u32 v5, v4, 4, v5
    buffer_load_dwordx4 v[64:67], v5, s[12:15], 0 offen offset:0
    buffer_load_dwordx4 v[68:71], v5, s[12:15], 0 offen offset:128
    buffer_load_dwordx4 v[72:75], v5, s[12:15], 0 offen offset:256
    buffer_load_dwordx4 v[76:79], v5, s[12:15], 0 offen offset:384
    buffer_load_dwordx4 v[80:83], v5, s[12:15], 0 offen offset:512
    buffer_load_dwordx4 v[84:87], v5, s[12:15], 0 offen offset:640
    buffer_load_dwordx4 v[88:91], v5, s[12:15], 0 offen offset:768
    buffer_load_dwordx4 v[92:95], v5, s[12:15], 0 offen offset:896
    s_mov_b32 s36, 0x3f803f80
    v_mov_b32 v24, 0
    v_mov_b32 v25, 0
    v_mov_b32 v26, 0
    v_mov_b32 v27, 0
    s_waitcnt vmcnt(0)
    v_lshlrev_b32 v28, 16, v64
    v_and_b32 v29, 0xffff0000, v64
    v_add_f32 v24, v24, v28
    v_add_f32 v25, v25, v29
    v_fma_f32 v26, v28, v28, v26
    v_fma_f32 v27, v29, v29, v27
    v_lshlrev_b32 v28, 16, v65
    v_and_b32 v29, 0xffff0000, v65
    v_add_f32 v24, v24, v28
    v_add_f32 v25, v25, v29
    v_fma_f32 v26, v28, v28, v26
    v_fma_f32 v27, v29, v29, v27
    v_lshlrev_b32 v28, 16, v66
    v_and_b32 v29, 0xffff0000, v66
    v_add_f32 v24, v24, v28
    v_add_f32 v25, v25, v29
    v_fma_f32 v26, v28, v28, v26
    v_fma_f32 v27, v29, v29, v27
    v_lshlrev_b32 v28, 16, v67
    v_and_b32 v29, 0xffff0000, v67
    v_add_f32 v24, v24, v28
    v_add_f32 v25, v25, v29
    v_fma_f32 v26, v28, v28, v26
    v_fma_f32 v27, v29, v29, v27
    v_lshlrev_b32 v28, 16, v68
    v_and_b32 v29, 0xffff0000, v68
    v_add_f32 v24, v24, v28
    v_add_f32 v25, v25, v29
    v_fma_f32 v26, v28, v28, v26
    v_fma_f32 v27, v29, v29, v27
    v_lshlrev_b32 v28, 16, v69
    v_and_b32 v29, 0xffff0000, v69
    v_add_f32 v24, v24, v28
    v_add_f32 v25, v25, v29
    v_fma_f32 v26, v28, v28, v26
    v_fma_f32 v27, v29, v29, v27
    v_lshlrev_b32 v28, 16, v70
    v_and_b32 v29, 0xffff0000, v70
    v_add_f32 v24, v24, v28
    v_add_f32 v25, v25, v29
    v_fma_f32 v26, v28, v28, v26
    v_fma_f32 v27, v29, v29, v27
    v_lshlrev_b32 v28, 16, v71
    v_and_b32 v29, 0xffff0000, v71
    v_add_f32 v24, v24, v28
    v_add_f32 v25, v25, v29
    v_fma_f32 v26, v28, v28, v26
    v_fma_f32 v27, v29, v29, v27
    v_lshlrev_b32 v28, 16, v72
    v_and_b32 v29, 0xffff0000, v72
    v_add_f32 v24, v24, v28
    v_add_f32 v25, v25, v29
    v_fma_f32 v26, v28, v28, v26
    v_fma_f32 v27, v29, v29, v27
    v_lshlrev_b32 v28, 16, v73
    v_and_b32 v29, 0xffff0000, v73
    v_add_f32 v24, v24, v28
    v_add_f32 v25, v25, v29
    v_fma_f32 v26, v28, v28, v26
    v_fma_f32 v27, v29, v29, v27
    v_lshlrev_b32 v28, 16, v74
    v_and_b32 v29, 0xffff0000, v74
    v_add_f32 v24, v24, v28
    v_add_f32 v25, v25, v29
    v_fma_f32 v26, v28, v28, v26
    v_fma_f32 v27, v29, v29, v27
    v_lshlrev_b32 v28, 16, v75
    v_and_b32 v29, 0xffff0000, v75
    v_add_f32 v24, v24, v28
    v_add_f32 v25, v25, v29
    v_fma_f32 v26, v28, v28, v26
    v_fma_f32 v27, v29, v29, v27
    v_lshlrev_b32 v28, 16, v76
    v_and_b32 v29, 0xffff0000, v76
    v_add_f32 v24, v24, v28
    v_add_f32 v25, v25, v29
    v_fma_f32 v26, v28, v28, v26
    v_fma_f32 v27, v29, v29, v27
    v_lshlrev_b32 v28, 16, v77
    v_and_b32 v29, 0xffff0000, v77
    v_add_f32 v24, v24, v28
    v_add_f32 v25, v25, v29
    v_fma_f32 v26, v28, v28, v26
    v_fma_f32 v27, v29, v29, v27
    v_lshlrev_b32 v28, 16, v78
    v_and_b32 v29, 0xffff0000, v78
    v_add_f32 v24, v24, v28
    v_add_f32 v25, v25, v29
    v_fma_f32 v26, v28, v28, v26
    v_fma_f32 v27, v29, v29, v27
    v_lshlrev_b32 v28, 16, v79
    v_and_b32 v29, 0xffff0000, v79
    v_add_f32 v24, v24, v28
    v_add_f32 v25, v25, v29
    v_fma_f32 v26, v28, v28, v26
    v_fma_f32 v27, v29, v29, v27
    v_lshlrev_b32 v28, 16, v80
    v_and_b32 v29, 0xffff0000, v80
    v_add_f32 v24, v24, v28
    v_add_f32 v25, v25, v29
    v_fma_f32 v26, v28, v28, v26
    v_fma_f32 v27, v29, v29, v27
    v_lshlrev_b32 v28, 16, v81
    v_and_b32 v29, 0xffff0000, v81
    v_add_f32 v24, v24, v28
    v_add_f32 v25, v25, v29
    v_fma_f32 v26, v28, v28, v26
    v_fma_f32 v27, v29, v29, v27
    v_lshlrev_b32 v28, 16, v82
    v_and_b32 v29, 0xffff0000, v82
    v_add_f32 v24, v24, v28
    v_add_f32 v25, v25, v29
    v_fma_f32 v26, v28, v28, v26
    v_fma_f32 v27, v29, v29, v27
    v_lshlrev_b32 v28, 16, v83
    v_and_b32 v29, 0xffff0000, v83
    v_add_f32 v24, v24, v28
    v_add_f32 v25, v25, v29
    v_fma_f32 v26, v28, v28, v26
    v_fma_f32 v27, v29, v29, v27
    v_lshlrev_b32 v28, 16, v84
    v_and_b32 v29, 0xffff0000, v84
    v_add_f32 v24, v24, v28
    v_add_f32 v25, v25, v29
    v_fma_f32 v26, v28, v28, v26
    v_fma_f32 v27, v29, v29, v27
    v_lshlrev_b32 v28, 16, v85
    v_and_b32 v29, 0xffff0000, v85
    v_add_f32 v24, v24, v28
    v_add_f32 v25, v25, v29
    v_fma_f32 v26, v28, v28, v26
    v_fma_f32 v27, v29, v29, v27
    v_lshlrev_b32 v28, 16, v86
    v_and_b32 v29, 0xffff0000, v86
    v_add_f32 v24, v24, v28
    v_add_f32 v25, v25, v29
    v_fma_f32 v26, v28, v28, v26
    v_fma_f32 v27, v29, v29, v27
    v_lshlrev_b32 v28, 16, v87
    v_and_b32 v29, 0xffff0000, v87
    v_add_f32 v24, v24, v28
    v_add_f32 v25, v25, v29
    v_fma_f32 v26, v28, v28, v26
    v_fma_f32 v27, v29, v29, v27
    v_lshlrev_b32 v28, 16, v88
    v_and_b32 v29, 0xffff0000, v88
    v_add_f32 v24, v24, v28
    v_add_f32 v25, v25, v29
    v_fma_f32 v26, v28, v28, v26
    v_fma_f32 v27, v29, v29, v27
    v_lshlrev_b32 v28, 16, v89
    v_and_b32 v29, 0xffff0000, v89
    v_add_f32 v24, v24, v28
    v_add_f32 v25, v25, v29
    v_fma_f32 v26, v28, v28, v26
    v_fma_f32 v27, v29, v29, v27
    v_lshlrev_b32 v28, 16, v90
    v_and_b32 v29, 0xffff0000, v90
    v_add_f32 v24, v24, v28
    v_add_f32 v25, v25, v29
    v_fma_f32 v26, v28, v28, v26
    v_fma_f32 v27, v29, v29, v27
    v_lshlrev_b32 v28, 16, v91
    v_and_b32 v29, 0xffff0000, v91
    v_add_f32 v24, v24, v28
    v_add_f32 v25, v25, v29
    v_fma_f32 v26, v28, v28, v26
    v_fma_f32 v27, v29, v29, v27
    v_lshlrev_b32 v28, 16, v92
    v_and_b32 v29, 0xffff0000, v92
    v_add_f32 v24, v24, v28
    v_add_f32 v25, v25, v29
    v_fma_f32 v26, v28, v28, v26
    v_fma_f32 v27, v29, v29, v27
    v_lshlrev_b32 v28, 16, v93
    v_and_b32 v29, 0xffff0000, v93
    v_add_f32 v24, v24, v28
    v_add_f32 v25, v25, v29
    v_fma_f32 v26, v28, v28, v26
    v_fma_f32 v27, v29, v29, v27
    v_lshlrev_b32 v28, 16, v94
    v_and_b32 v29, 0xffff0000, v94
    v_add_f32 v24, v24, v28
    v_add_f32 v25, v25, v29
    v_fma_f32 v26, v28, v28, v26
    v_fma_f32 v27, v29, v29, v27
    v_lshlrev_b32 v28, 16, v95
    v_and_b32 v29, 0xffff0000, v95
    v_add_f32 v24, v24, v28
    v_add_f32 v25, v25, v29
    v_fma_f32 v26, v28, v28, v26
    v_fma_f32 v27, v29, v29, v27
    v_add_f32 v24, v24, v25
    v_add_f32 v26, v26, v27
    s_nop 0
    v_add_f32_dpp v24, v24, v24 quad_perm:[1,0,3,2] row_mask:0xf bank_mask:0xf
    v_add_f32_dpp v26, v26, v26 quad_perm:[1,0,3,2] row_mask:0xf bank_mask:0xf
    s_nop 0
    v_add_f32_dpp v24, v24, v24 quad_perm:[2,3,0,1] row_mask:0xf bank_mask:0xf
    v_add_f32_dpp v26, v26, v26 quad_perm:[2,3,0,1] row_mask:0xf bank_mask:0xf
    s_nop 0
    v_add_f32_dpp v24, v24, v24 row_half_mirror row_mask:0xf bank_mask:0xf
    v_add_f32_dpp v26, v26, v26 row_half_mirror row_mask:0xf bank_mask:0xf
    v_mul_f32 v24, 0x3b000000, v24
    v_mul_f32 v26, 0x3b000000, v26
    v_fma_f32 v26, -v24, v24, v26
    v_max_f32 v26, 0, v26
    v_cvt_pk_bf16_f32 v24, v24, v24
    v_lshlrev_b32 v24, 16, v24
    v_cvt_pk_bf16_f32 v26, v26, v26
    v_lshlrev_b32 v26, 16, v26
    v_add_f32 v26, 0x3727c5ac, v26
    v_cvt_pk_bf16_f32 v26, v26, v26
    v_lshlrev_b32 v26, 16, v26
    v_sqrt_f32 v26, v26
    s_nop 0
    v_cvt_pk_bf16_f32 v26, v26, v26
    v_lshlrev_b32 v26, 16, v26
    v_rcp_f32 v26, v26
    s_nop 0
    v_mul_f32 v24, v24, v26
    v_sub_f32 v24, 0, v24
    v_and_b32 v6, 15, v3
    v_lshlrev_b32 v7, 10, v3
    v_add_u32 v28, 0, v4
    v_xor_b32 v28, v28, v6
    v_lshl_add_u32 v28, v28, 4, v7
    v_add_u32 v29, 8, v4
    v_xor_b32 v29, v29, v6
    v_lshl_add_u32 v29, v29, 4, v7
    v_lshlrev_b32 v32, 16, v64
    v_and_b32 v33, 0xffff0000, v64
    v_fma_f32 v32, v32, v26, v24
    v_fma_f32 v33, v33, v26, v24
    v_cvt_pk_bf16_f32 v64, v32, v33
    v_lshlrev_b32 v32, 16, v65
    v_and_b32 v33, 0xffff0000, v65
    v_fma_f32 v32, v32, v26, v24
    v_fma_f32 v33, v33, v26, v24
    v_cvt_pk_bf16_f32 v65, v32, v33
    v_lshlrev_b32 v32, 16, v66
    v_and_b32 v33, 0xffff0000, v66
    v_fma_f32 v32, v32, v26, v24
    v_fma_f32 v33, v33, v26, v24
    v_cvt_pk_bf16_f32 v66, v32, v33
    v_lshlrev_b32 v32, 16, v67
    v_and_b32 v33, 0xffff0000, v67
    v_fma_f32 v32, v32, v26, v24
    v_fma_f32 v33, v33, v26, v24
    v_cvt_pk_bf16_f32 v67, v32, v33
    ds_write_b128 v28, v[64:67] offset:0
    v_lshlrev_b32 v32, 16, v68
    v_and_b32 v33, 0xffff0000, v68
    v_fma_f32 v32, v32, v26, v24
    v_fma_f32 v33, v33, v26, v24
    v_cvt_pk_bf16_f32 v68, v32, v33
    v_lshlrev_b32 v32, 16, v69
    v_and_b32 v33, 0xffff0000, v69
    v_fma_f32 v32, v32, v26, v24
    v_fma_f32 v33, v33, v26, v24
    v_cvt_pk_bf16_f32 v69, v32, v33
    v_lshlrev_b32 v32, 16, v70
    v_and_b32 v33, 0xffff0000, v70
    v_fma_f32 v32, v32, v26, v24
    v_fma_f32 v33, v33, v26, v24
    v_cvt_pk_bf16_f32 v70, v32, v33
    v_lshlrev_b32 v32, 16, v71
    v_and_b32 v33, 0xffff0000, v71
    v_fma_f32 v32, v32, v26, v24
    v_fma_f32 v33, v33, v26, v24
    v_cvt_pk_bf16_f32 v71, v32, v33
    ds_write_b128 v29, v[68:71] offset:0
    v_lshlrev_b32 v32, 16, v72
    v_and_b32 v33, 0xffff0000, v72
    v_fma_f32 v32, v32, v26, v24
    v_fma_f32 v33, v33, v26, v24
    v_cvt_pk_bf16_f32 v72, v32, v33
    v_lshlrev_b32 v32, 16, v73
    v_and_b32 v33, 0xffff0000, v73
    v_fma_f32 v32, v32, v26, v24
    v_fma_f32 v33, v33, v26, v24
    v_cvt_pk_bf16_f32 v73, v32, v33
    v_lshlrev_b32 v32, 16, v74
    v_and_b32 v33, 0xffff0000, v74
    v_fma_f32 v32, v32, v26, v24
    v_fma_f32 v33, v33, v26, v24
    v_cvt_pk_bf16_f32 v74, v32, v33
    v_lshlrev_b32 v32, 16, v75
    v_and_b32 v33, 0xffff0000, v75
    v_fma_f32 v32, v32, v26, v24
    v_fma_f32 v33, v33, v26, v24
    v_cvt_pk_bf16_f32 v75, v32, v33
    ds_write_b128 v28, v[72:75] offset:256
    v_lshlrev_b32 v32, 16, v76
    v_and_b32 v33, 0xffff0000, v76
    v_fma_f32 v32, v32, v26, v24
    v_fma_f32 v33, v33, v26, v24
    v_cvt_pk_bf16_f32 v76, v32, v33
    v_lshlrev_b32 v32, 16, v77
    v_and_b32 v33, 0xffff0000, v77
    v_fma_f32 v32, v32, v26, v24
    v_fma_f32 v33, v33, v26, v24
    v_cvt_pk_bf16_f32 v77, v32, v33
    v_lshlrev_b32 v32, 16, v78
    v_and_b32 v33, 0xffff0000, v78
    v_fma_f32 v32, v32, v26, v24
    v_fma_f32 v33, v33, v26, v24
    v_cvt_pk_bf16_f32 v78, v32, v33
    v_lshlrev_b32 v32, 16, v79
    v_and_b32 v33, 0xffff0000, v79
    v_fma_f32 v32, v32, v26, v24
    v_fma_f32 v33, v33, v26, v24
    v_cvt_pk_bf16_f32 v79, v32, v33
    ds_write_b128 v29, v[76:79] offset:256
    v_lshlrev_b32 v32, 16, v80
    v_and_b32 v33, 0xffff0000, v80
    v_fma_f32 v32, v32, v26, v24
    v_fma_f32 v33, v33, v26, v24
    v_cvt_pk_bf16_f32 v80, v32, v33
    v_lshlrev_b32 v32, 16, v81
    v_and_b32 v33, 0xffff0000, v81
    v_fma_f32 v32, v32, v26, v24
    v_fma_f32 v33, v33, v26, v24
    v_cvt_pk_bf16_f32 v81, v32, v33
    v_lshlrev_b32 v32, 16, v82
    v_and_b32 v33, 0xffff0000, v82
    v_fma_f32 v32, v32, v26, v24
    v_fma_f32 v33, v33, v26, v24
    v_cvt_pk_bf16_f32 v82, v32, v33
    v_lshlrev_b32 v32, 16, v83
    v_and_b32 v33, 0xffff0000, v83
    v_fma_f32 v32, v32, v26, v24
    v_fma_f32 v33, v33, v26, v24
    v_cvt_pk_bf16_f32 v83, v32, v33
    ds_write_b128 v28, v[80:83] offset:512
    v_lshlrev_b32 v32, 16, v84
    v_and_b32 v33, 0xffff0000, v84
    v_fma_f32 v32, v32, v26, v24
    v_fma_f32 v33, v33, v26, v24
    v_cvt_pk_bf16_f32 v84, v32, v33
    v_lshlrev_b32 v32, 16, v85
    v_and_b32 v33, 0xffff0000, v85
    v_fma_f32 v32, v32, v26, v24
    v_fma_f32 v33, v33, v26, v24
    v_cvt_pk_bf16_f32 v85, v32, v33
    v_lshlrev_b32 v32, 16, v86
    v_and_b32 v33, 0xffff0000, v86
    v_fma_f32 v32, v32, v26, v24
    v_fma_f32 v33, v33, v26, v24
    v_cvt_pk_bf16_f32 v86, v32, v33
    v_lshlrev_b32 v32, 16, v87
    v_and_b32 v33, 0xffff0000, v87
    v_fma_f32 v32, v32, v26, v24
    v_fma_f32 v33, v33, v26, v24
    v_cvt_pk_bf16_f32 v87, v32, v33
    ds_write_b128 v29, v[84:87] offset:512
    v_lshlrev_b32 v32, 16, v88
    v_and_b32 v33, 0xffff0000, v88
    v_fma_f32 v32, v32, v26, v24
    v_fma_f32 v33, v33, v26, v24
    v_cvt_pk_bf16_f32 v88, v32, v33
    v_lshlrev_b32 v32, 16, v89
    v_and_b32 v33, 0xffff0000, v89
    v_fma_f32 v32, v32, v26, v24
    v_fma_f32 v33, v33, v26, v24
    v_cvt_pk_bf16_f32 v89, v32, v33
    v_lshlrev_b32 v32, 16, v90
    v_and_b32 v33, 0xffff0000, v90
    v_fma_f32 v32, v32, v26, v24
    v_fma_f32 v33, v33, v26, v24
    v_cvt_pk_bf16_f32 v90, v32, v33
    v_lshlrev_b32 v32, 16, v91
    v_and_b32 v33, 0xffff0000, v91
    v_fma_f32 v32, v32, v26, v24
    v_fma_f32 v33, v33, v26, v24
    v_cvt_pk_bf16_f32 v91, v32, v33
    ds_write_b128 v28, v[88:91] offset:768
    v_lshlrev_b32 v32, 16, v92
    v_and_b32 v33, 0xffff0000, v92
    v_fma_f32 v32, v32, v26, v24
    v_fma_f32 v33, v33, v26, v24
    v_cvt_pk_bf16_f32 v92, v32, v33
    v_lshlrev_b32 v32, 16, v93
    v_and_b32 v33, 0xffff0000, v93
    v_fma_f32 v32, v32, v26, v24
    v_fma_f32 v33, v33, v26, v24
    v_cvt_pk_bf16_f32 v93, v32, v33
    v_lshlrev_b32 v32, 16, v94
    v_and_b32 v33, 0xffff0000, v94
    v_fma_f32 v32, v32, v26, v24
    v_fma_f32 v33, v33, v26, v24
    v_cvt_pk_bf16_f32 v94, v32, v33
    v_lshlrev_b32 v32, 16, v95
    v_and_b32 v33, 0xffff0000, v95
    v_fma_f32 v32, v32, v26, v24
    v_fma_f32 v33, v33, v26, v24
    v_cvt_pk_bf16_f32 v95, v32, v33
    ds_write_b128 v29, v[92:95] offset:768
    v_lshrrev_b32 v3, 4, v1
    v_and_b32 v4, 15, v1
    s_lshr_b32 s37, s30, 1
    s_lshl_b32 s37, s37, 14
    v_lshlrev_b32 v5, 10, v4
    v_add_u32 v5, s37, v5
    v_add_u32 v36, 0, v3
    v_xor_b32 v36, v36, v4
    v_lshl_add_u32 v36, v36, 4, v5
    v_add_u32 v37, 4, v3
    v_xor_b32 v37, v37, v4
    v_lshl_add_u32 v37, v37, 4, v5
    v_add_u32 v38, 8, v3
    v_xor_b32 v38, v38, v4
    v_lshl_add_u32 v38, v38, 4, v5
    v_add_u32 v39, 12, v3
    v_xor_b32 v39, v39, v4
    v_lshl_add_u32 v39, v39, 4, v5
    v_lshrrev_b32 v5, 1, v3
    v_lshlrev_b32 v5, 4, v5
    v_and_b32 v6, 1, v3
    v_lshl_add_u32 v5, v6, 2, v5
    v_lshrrev_b32 v6, 2, v4
    v_add_u32 v5, v5, v6
    s_mov_b32 s34, 480
    v_mul_u32_u24 v5, s34, v5
    v_and_b32 v6, 3, v4
    v_lshl_add_u32 v5, v6, 3, v5
    s_and_b32 s38, s30, 1
    s_mul_i32 s38, s38, 224
    s_add_u32 s38, s38, 65536
    v_add_u32 v40, s38, v5
    s_mov_b32 s35, 458752
    buffer_load_dwordx4 v[100:103], v8, s[16:19], s35 offen
    buffer_load_dwordx4 v[104:107], v9, s[16:19], s35 offen
    buffer_load_dwordx4 v[108:111], v10, s[16:19], s35 offen
    buffer_load_dwordx4 v[112:115], v11, s[16:19], s35 offen
    s_waitcnt vmcnt(8)
    ds_write_b128 v16, v[184:187] offset:0
    ds_write_b128 v17, v[188:191] offset:0
    ds_write_b128 v18, v[192:195] offset:0
    s_mov_b64 exec, s[46:47]
    ds_write_b128 v19, v[196:199] offset:0
    s_mov_b64 exec, -1
    s_mov_b32 s35, 688128
    buffer_load_dwordx4 v[184:187], v8, s[16:19], s35 offen
    buffer_load_dwordx4 v[188:191], v9, s[16:19], s35 offen
    buffer_load_dwordx4 v[192:195], v10, s[16:19], s35 offen
    buffer_load_dwordx4 v[196:199], v11, s[16:19], s35 offen
    s_waitcnt lgkmcnt(0)
    s_barrier
    s_mov_b32 s42, 0
    s_mov_b32 s43, 28672
    s_mov_b32 s40, 0x3d372713
    s_mov_b32 s41, 0xc0135761
    v_mov_b32 v128, 0
    v_mov_b32 v129, 0
    v_mov_b32 v130, 0
    v_mov_b32 v131, 0
    v_mov_b32 v132, 0
    v_mov_b32 v133, 0
    v_mov_b32 v134, 0
    v_mov_b32 v135, 0
    v_mov_b32 v136, 0
    v_mov_b32 v137, 0
    v_mov_b32 v138, 0
    v_mov_b32 v139, 0
    v_mov_b32 v140, 0
    v_mov_b32 v141, 0
    v_mov_b32 v142, 0
    v_mov_b32 v143, 0
    v_mov_b32 v144, 0
    v_mov_b32 v145, 0
    v_mov_b32 v146, 0
    v_mov_b32 v147, 0
    v_mov_b32 v148, 0
    v_mov_b32 v149, 0
    v_mov_b32 v150, 0
    v_mov_b32 v151, 0
    v_mov_b32 v152, 0
    v_mov_b32 v153, 0
    v_mov_b32 v154, 0
    v_mov_b32 v155, 0
    ds_read_b128 v[64:67], v36 offset:0
    ds_read_b64_tr_b16 v[72:73], v40 offset:0
    ds_read_b64_tr_b16 v[74:75], v40 offset:3840
    ds_read_b64_tr_b16 v[76:77], v40 offset:32
    ds_read_b64_tr_b16 v[78:79], v40 offset:3872
    ds_read_b64_tr_b16 v[80:81], v40 offset:64
    ds_read_b64_tr_b16 v[82:83], v40 offset:3904
    ds_read_b64_tr_b16 v[84:85], v40 offset:96
    ds_read_b64_tr_b16 v[86:87], v40 offset:3936
    ds_read_b64_tr_b16 v[88:89], v40 offset:128
    ds_read_b64_tr_b16 v[90:91], v40 offset:3968
    ds_read_b64_tr_b16 v[92:93], v40 offset:160
    ds_read_b64_tr_b16 v[94:95], v40 offset:4000
    ds_read_b64_tr_b16 v[96:97], v40 offset:192
    ds_read_b64_tr_b16 v[98:99], v40 offset:4032
    s_waitcnt lgkmcnt(12)
    v_mfma_f32_16x16x32_bf16 v[128:131], v[72:75], v[64:67], v[128:131]
    s_waitcnt lgkmcnt(10)
    v_mfma_f32_16x16x32_bf16 v[132:135], v[76:79], v[64:67], v[132:135]
    s_waitcnt lgkmcnt(8)
    v_mfma_f32_16x16x32_bf16 v[136:139], v[80:83], v[64:67], v[136:139]
    s_waitcnt lgkmcnt(6)
    v_mfma_f32_16x16x32_bf16 v[140:143], v[84:87], v[64:67], v[140:143]
    s_waitcnt lgkmcnt(4)
    v_mfma_f32_16x16x32_bf16 v[144:147], v[88:91], v[64:67], v[144:147]
    s_waitcnt lgkmcnt(2)
    v_mfma_f32_16x16x32_bf16 v[148:151], v[92:95], v[64:67], v[148:151]
    s_waitcnt lgkmcnt(0)
    v_mfma_f32_16x16x32_bf16 v[152:155], v[96:99], v[64:67], v[152:155]
    ds_read_b128 v[64:67], v37 offset:0
    ds_read_b64_tr_b16 v[72:73], v40 offset:15360
    ds_read_b64_tr_b16 v[74:75], v40 offset:19200
    ds_read_b64_tr_b16 v[76:77], v40 offset:15392
    ds_read_b64_tr_b16 v[78:79], v40 offset:19232
    ds_read_b64_tr_b16 v[80:81], v40 offset:15424
    ds_read_b64_tr_b16 v[82:83], v40 offset:19264
    ds_read_b64_tr_b16 v[84:85], v40 offset:15456
    ds_read_b64_tr_b16 v[86:87], v40 offset:19296
    ds_read_b64_tr_b16 v[88:89], v40 offset:15488
    ds_read_b64_tr_b16 v[90:91], v40 offset:19328
    ds_read_b64_tr_b16 v[92:93], v40 offset:15520
    ds_read_b64_tr_b16 v[94:95], v40 offset:19360
    ds_read_b64_tr_b16 v[96:97], v40 offset:15552
    ds_read_b64_tr_b16 v[98:99], v40 offset:19392
    s_waitcnt lgkmcnt(12)
    v_mfma_f32_16x16x32_bf16 v[128:131], v[72:75], v[64:67], v[128:131]
    s_waitcnt lgkmcnt(10)
    v_mfma_f32_16x16x32_bf16 v[132:135], v[76:79], v[64:67], v[132:135]
    s_waitcnt lgkmcnt(8)
    v_mfma_f32_16x16x32_bf16 v[136:139], v[80:83], v[64:67], v[136:139]
    s_waitcnt lgkmcnt(6)
    v_mfma_f32_16x16x32_bf16 v[140:143], v[84:87], v[64:67], v[140:143]
    s_waitcnt lgkmcnt(4)
    v_mfma_f32_16x16x32_bf16 v[144:147], v[88:91], v[64:67], v[144:147]
    s_waitcnt lgkmcnt(2)
    v_mfma_f32_16x16x32_bf16 v[148:151], v[92:95], v[64:67], v[148:151]
    s_waitcnt lgkmcnt(0)
    v_mfma_f32_16x16x32_bf16 v[152:155], v[96:99], v[64:67], v[152:155]
    s_waitcnt vmcnt(8)
    ds_write_b128 v16, v[212:215] offset:30720
    ds_write_b128 v17, v[216:219] offset:30720
    ds_write_b128 v18, v[220:223] offset:30720
    s_mov_b64 exec, s[46:47]
    ds_write_b128 v19, v[224:227] offset:30720
    s_mov_b64 exec, -1
    s_mov_b32 s35, 917504
    buffer_load_dwordx4 v[212:215], v8, s[16:19], s35 offen
    buffer_load_dwordx4 v[216:219], v9, s[16:19], s35 offen
    buffer_load_dwordx4 v[220:223], v10, s[16:19], s35 offen
    buffer_load_dwordx4 v[224:227], v11, s[16:19], s35 offen
    s_waitcnt lgkmcnt(0)
    s_barrier
    ds_read_b128 v[64:67], v38 offset:0
    ds_read_b64_tr_b16 v[72:73], v40 offset:30720
    ds_read_b64_tr_b16 v[74:75], v40 offset:34560
    ds_read_b64_tr_b16 v[76:77], v40 offset:30752
    ds_read_b64_tr_b16 v[78:79], v40 offset:34592
    ds_read_b64_tr_b16 v[80:81], v40 offset:30784
    ds_read_b64_tr_b16 v[82:83], v40 offset:34624
    ds_read_b64_tr_b16 v[84:85], v40 offset:30816
    ds_read_b64_tr_b16 v[86:87], v40 offset:34656
    ds_read_b64_tr_b16 v[88:89], v40 offset:30848
    ds_read_b64_tr_b16 v[90:91], v40 offset:34688
    ds_read_b64_tr_b16 v[92:93], v40 offset:30880
    ds_read_b64_tr_b16 v[94:95], v40 offset:34720
    ds_read_b64_tr_b16 v[96:97], v40 offset:30912
    ds_read_b64_tr_b16 v[98:99], v40 offset:34752
    s_waitcnt lgkmcnt(12)
    v_mfma_f32_16x16x32_bf16 v[128:131], v[72:75], v[64:67], v[128:131]
    s_waitcnt lgkmcnt(10)
    v_mfma_f32_16x16x32_bf16 v[132:135], v[76:79], v[64:67], v[132:135]
    s_waitcnt lgkmcnt(8)
    v_mfma_f32_16x16x32_bf16 v[136:139], v[80:83], v[64:67], v[136:139]
    s_waitcnt lgkmcnt(6)
    v_mfma_f32_16x16x32_bf16 v[140:143], v[84:87], v[64:67], v[140:143]
    s_waitcnt lgkmcnt(4)
    v_mfma_f32_16x16x32_bf16 v[144:147], v[88:91], v[64:67], v[144:147]
    s_waitcnt lgkmcnt(2)
    v_mfma_f32_16x16x32_bf16 v[148:151], v[92:95], v[64:67], v[148:151]
    s_waitcnt lgkmcnt(0)
    v_mfma_f32_16x16x32_bf16 v[152:155], v[96:99], v[64:67], v[152:155]
    ds_read_b128 v[64:67], v39 offset:0
    ds_read_b64_tr_b16 v[72:73], v40 offset:46080
    ds_read_b64_tr_b16 v[74:75], v40 offset:49920
    ds_read_b64_tr_b16 v[76:77], v40 offset:46112
    ds_read_b64_tr_b16 v[78:79], v40 offset:49952
    ds_read_b64_tr_b16 v[80:81], v40 offset:46144
    ds_read_b64_tr_b16 v[82:83], v40 offset:49984
    ds_read_b64_tr_b16 v[84:85], v40 offset:46176
    ds_read_b64_tr_b16 v[86:87], v40 offset:50016
    ds_read_b64_tr_b16 v[88:89], v40 offset:46208
    ds_read_b64_tr_b16 v[90:91], v40 offset:50048
    ds_read_b64_tr_b16 v[92:93], v40 offset:46240
    ds_read_b64_tr_b16 v[94:95], v40 offset:50080
    ds_read_b64_tr_b16 v[96:97], v40 offset:46272
    ds_read_b64_tr_b16 v[98:99], v40 offset:50112
    s_waitcnt lgkmcnt(12)
    v_mfma_f32_16x16x32_bf16 v[128:131], v[72:75], v[64:67], v[128:131]
    s_waitcnt lgkmcnt(10)
    v_mfma_f32_16x16x32_bf16 v[132:135], v[76:79], v[64:67], v[132:135]
    s_waitcnt lgkmcnt(8)
    v_mfma_f32_16x16x32_bf16 v[136:139], v[80:83], v[64:67], v[136:139]
    s_waitcnt lgkmcnt(6)
    v_mfma_f32_16x16x32_bf16 v[140:143], v[84:87], v[64:67], v[140:143]
    s_waitcnt lgkmcnt(4)
    v_mfma_f32_16x16x32_bf16 v[144:147], v[88:91], v[64:67], v[144:147]
    s_waitcnt lgkmcnt(2)
    v_mfma_f32_16x16x32_bf16 v[148:151], v[92:95], v[64:67], v[148:151]
    s_waitcnt lgkmcnt(0)
    v_mfma_f32_16x16x32_bf16 v[152:155], v[96:99], v[64:67], v[152:155]
    s_waitcnt vmcnt(8)
    ds_write_b128 v16, v[100:103] offset:0
    ds_write_b128 v17, v[104:107] offset:0
    ds_write_b128 v18, v[108:111] offset:0
    s_mov_b64 exec, s[46:47]
    ds_write_b128 v19, v[112:115] offset:0
    s_mov_b64 exec, -1
    s_mov_b32 s35, 1146880
    buffer_load_dwordx4 v[100:103], v8, s[16:19], s35 offen
    buffer_load_dwordx4 v[104:107], v9, s[16:19], s35 offen
    buffer_load_dwordx4 v[108:111], v10, s[16:19], s35 offen
    buffer_load_dwordx4 v[112:115], v11, s[16:19], s35 offen
    s_waitcnt lgkmcnt(0)
    s_barrier
    ds_read_b128 v[64:67], v36 offset:256
    ds_read_b64_tr_b16 v[72:73], v40 offset:0
    ds_read_b64_tr_b16 v[74:75], v40 offset:3840
    ds_read_b64_tr_b16 v[76:77], v40 offset:32
    ds_read_b64_tr_b16 v[78:79], v40 offset:3872
    ds_read_b64_tr_b16 v[80:81], v40 offset:64
    ds_read_b64_tr_b16 v[82:83], v40 offset:3904
    ds_read_b64_tr_b16 v[84:85], v40 offset:96
    ds_read_b64_tr_b16 v[86:87], v40 offset:3936
    ds_read_b64_tr_b16 v[88:89], v40 offset:128
    ds_read_b64_tr_b16 v[90:91], v40 offset:3968
    ds_read_b64_tr_b16 v[92:93], v40 offset:160
    ds_read_b64_tr_b16 v[94:95], v40 offset:4000
    ds_read_b64_tr_b16 v[96:97], v40 offset:192
    ds_read_b64_tr_b16 v[98:99], v40 offset:4032
    s_waitcnt lgkmcnt(12)
    v_mfma_f32_16x16x32_bf16 v[128:131], v[72:75], v[64:67], v[128:131]
    s_waitcnt lgkmcnt(10)
    v_mfma_f32_16x16x32_bf16 v[132:135], v[76:79], v[64:67], v[132:135]
    s_waitcnt lgkmcnt(8)
    v_mfma_f32_16x16x32_bf16 v[136:139], v[80:83], v[64:67], v[136:139]
    s_waitcnt lgkmcnt(6)
    v_mfma_f32_16x16x32_bf16 v[140:143], v[84:87], v[64:67], v[140:143]
    s_waitcnt lgkmcnt(4)
    v_mfma_f32_16x16x32_bf16 v[144:147], v[88:91], v[64:67], v[144:147]
    s_waitcnt lgkmcnt(2)
    v_mfma_f32_16x16x32_bf16 v[148:151], v[92:95], v[64:67], v[148:151]
    s_waitcnt lgkmcnt(0)
    v_mfma_f32_16x16x32_bf16 v[152:155], v[96:99], v[64:67], v[152:155]
    ds_read_b128 v[64:67], v37 offset:256
    ds_read_b64_tr_b16 v[72:73], v40 offset:15360
    ds_read_b64_tr_b16 v[74:75], v40 offset:19200
    ds_read_b64_tr_b16 v[76:77], v40 offset:15392
    ds_read_b64_tr_b16 v[78:79], v40 offset:19232
    ds_read_b64_tr_b16 v[80:81], v40 offset:15424
    ds_read_b64_tr_b16 v[82:83], v40 offset:19264
    ds_read_b64_tr_b16 v[84:85], v40 offset:15456
    ds_read_b64_tr_b16 v[86:87], v40 offset:19296
    ds_read_b64_tr_b16 v[88:89], v40 offset:15488
    ds_read_b64_tr_b16 v[90:91], v40 offset:19328
    ds_read_b64_tr_b16 v[92:93], v40 offset:15520
    ds_read_b64_tr_b16 v[94:95], v40 offset:19360
    ds_read_b64_tr_b16 v[96:97], v40 offset:15552
    ds_read_b64_tr_b16 v[98:99], v40 offset:19392
    s_waitcnt lgkmcnt(12)
    v_mfma_f32_16x16x32_bf16 v[128:131], v[72:75], v[64:67], v[128:131]
    s_waitcnt lgkmcnt(10)
    v_mfma_f32_16x16x32_bf16 v[132:135], v[76:79], v[64:67], v[132:135]
    s_waitcnt lgkmcnt(8)
    v_mfma_f32_16x16x32_bf16 v[136:139], v[80:83], v[64:67], v[136:139]
    s_waitcnt lgkmcnt(6)
    v_mfma_f32_16x16x32_bf16 v[140:143], v[84:87], v[64:67], v[140:143]
    s_waitcnt lgkmcnt(4)
    v_mfma_f32_16x16x32_bf16 v[144:147], v[88:91], v[64:67], v[144:147]
    s_waitcnt lgkmcnt(2)
    v_mfma_f32_16x16x32_bf16 v[148:151], v[92:95], v[64:67], v[148:151]
    s_waitcnt lgkmcnt(0)
    v_mfma_f32_16x16x32_bf16 v[152:155], v[96:99], v[64:67], v[152:155]
    s_waitcnt vmcnt(8)
    ds_write_b128 v16, v[184:187] offset:30720
    ds_write_b128 v17, v[188:191] offset:30720
    ds_write_b128 v18, v[192:195] offset:30720
    s_mov_b64 exec, s[46:47]
    ds_write_b128 v19, v[196:199] offset:30720
    s_mov_b64 exec, -1
    s_mov_b32 s35, 1376256
    buffer_load_dwordx4 v[184:187], v8, s[16:19], s35 offen
    buffer_load_dwordx4 v[188:191], v9, s[16:19], s35 offen
    buffer_load_dwordx4 v[192:195], v10, s[16:19], s35 offen
    buffer_load_dwordx4 v[196:199], v11, s[16:19], s35 offen
    s_waitcnt lgkmcnt(0)
    s_barrier
    ds_read_b128 v[64:67], v38 offset:256
    ds_read_b64_tr_b16 v[72:73], v40 offset:30720
    ds_read_b64_tr_b16 v[74:75], v40 offset:34560
    ds_read_b64_tr_b16 v[76:77], v40 offset:30752
    ds_read_b64_tr_b16 v[78:79], v40 offset:34592
    ds_read_b64_tr_b16 v[80:81], v40 offset:30784
    ds_read_b64_tr_b16 v[82:83], v40 offset:34624
    ds_read_b64_tr_b16 v[84:85], v40 offset:30816
    ds_read_b64_tr_b16 v[86:87], v40 offset:34656
    ds_read_b64_tr_b16 v[88:89], v40 offset:30848
    ds_read_b64_tr_b16 v[90:91], v40 offset:34688
    ds_read_b64_tr_b16 v[92:93], v40 offset:30880
    ds_read_b64_tr_b16 v[94:95], v40 offset:34720
    ds_read_b64_tr_b16 v[96:97], v40 offset:30912
    ds_read_b64_tr_b16 v[98:99], v40 offset:34752
    s_waitcnt lgkmcnt(12)
    v_mfma_f32_16x16x32_bf16 v[128:131], v[72:75], v[64:67], v[128:131]
    s_waitcnt lgkmcnt(10)
    v_mfma_f32_16x16x32_bf16 v[132:135], v[76:79], v[64:67], v[132:135]
    s_waitcnt lgkmcnt(8)
    v_mfma_f32_16x16x32_bf16 v[136:139], v[80:83], v[64:67], v[136:139]
    s_waitcnt lgkmcnt(6)
    v_mfma_f32_16x16x32_bf16 v[140:143], v[84:87], v[64:67], v[140:143]
    s_waitcnt lgkmcnt(4)
    v_mfma_f32_16x16x32_bf16 v[144:147], v[88:91], v[64:67], v[144:147]
    s_waitcnt lgkmcnt(2)
    v_mfma_f32_16x16x32_bf16 v[148:151], v[92:95], v[64:67], v[148:151]
    s_waitcnt lgkmcnt(0)
    v_mfma_f32_16x16x32_bf16 v[152:155], v[96:99], v[64:67], v[152:155]
    ds_read_b128 v[64:67], v39 offset:256
    ds_read_b64_tr_b16 v[72:73], v40 offset:46080
    ds_read_b64_tr_b16 v[74:75], v40 offset:49920
    ds_read_b64_tr_b16 v[76:77], v40 offset:46112
    ds_read_b64_tr_b16 v[78:79], v40 offset:49952
    ds_read_b64_tr_b16 v[80:81], v40 offset:46144
    ds_read_b64_tr_b16 v[82:83], v40 offset:49984
    ds_read_b64_tr_b16 v[84:85], v40 offset:46176
    ds_read_b64_tr_b16 v[86:87], v40 offset:50016
    ds_read_b64_tr_b16 v[88:89], v40 offset:46208
    ds_read_b64_tr_b16 v[90:91], v40 offset:50048
    ds_read_b64_tr_b16 v[92:93], v40 offset:46240
    ds_read_b64_tr_b16 v[94:95], v40 offset:50080
    ds_read_b64_tr_b16 v[96:97], v40 offset:46272
    ds_read_b64_tr_b16 v[98:99], v40 offset:50112
    s_waitcnt lgkmcnt(12)
    v_mfma_f32_16x16x32_bf16 v[128:131], v[72:75], v[64:67], v[128:131]
    s_waitcnt lgkmcnt(10)
    v_mfma_f32_16x16x32_bf16 v[132:135], v[76:79], v[64:67], v[132:135]
    s_waitcnt lgkmcnt(8)
    v_mfma_f32_16x16x32_bf16 v[136:139], v[80:83], v[64:67], v[136:139]
    s_waitcnt lgkmcnt(6)
    v_mfma_f32_16x16x32_bf16 v[140:143], v[84:87], v[64:67], v[140:143]
    s_waitcnt lgkmcnt(4)
    v_mfma_f32_16x16x32_bf16 v[144:147], v[88:91], v[64:67], v[144:147]
    s_waitcnt lgkmcnt(2)
    v_mfma_f32_16x16x32_bf16 v[148:151], v[92:95], v[64:67], v[148:151]
    s_waitcnt lgkmcnt(0)
    v_mfma_f32_16x16x32_bf16 v[152:155], v[96:99], v[64:67], v[152:155]
    s_waitcnt vmcnt(8)
    ds_write_b128 v16, v[212:215] offset:0
    ds_write_b128 v17, v[216:219] offset:0
    ds_write_b128 v18, v[220:223] offset:0
    s_mov_b64 exec, s[46:47]
    ds_write_b128 v19, v[224:227] offset:0
    s_mov_b64 exec, -1
    s_mov_b32 s35, 1605632
    buffer_load_dwordx4 v[212:215], v8, s[16:19], s35 offen
    buffer_load_dwordx4 v[216:219], v9, s[16:19], s35 offen
    buffer_load_dwordx4 v[220:223], v10, s[16:19], s35 offen
    buffer_load_dwordx4 v[224:227], v11, s[16:19], s35 offen
    s_waitcnt lgkmcnt(0)
    s_barrier
    ds_read_b128 v[64:67], v36 offset:512
    ds_read_b64_tr_b16 v[72:73], v40 offset:0
    ds_read_b64_tr_b16 v[74:75], v40 offset:3840
    ds_read_b64_tr_b16 v[76:77], v40 offset:32
    ds_read_b64_tr_b16 v[78:79], v40 offset:3872
    ds_read_b64_tr_b16 v[80:81], v40 offset:64
    ds_read_b64_tr_b16 v[82:83], v40 offset:3904
    ds_read_b64_tr_b16 v[84:85], v40 offset:96
    ds_read_b64_tr_b16 v[86:87], v40 offset:3936
    ds_read_b64_tr_b16 v[88:89], v40 offset:128
    ds_read_b64_tr_b16 v[90:91], v40 offset:3968
    ds_read_b64_tr_b16 v[92:93], v40 offset:160
    ds_read_b64_tr_b16 v[94:95], v40 offset:4000
    ds_read_b64_tr_b16 v[96:97], v40 offset:192
    ds_read_b64_tr_b16 v[98:99], v40 offset:4032
    s_waitcnt lgkmcnt(12)
    v_mfma_f32_16x16x32_bf16 v[128:131], v[72:75], v[64:67], v[128:131]
    s_waitcnt lgkmcnt(10)
    v_mfma_f32_16x16x32_bf16 v[132:135], v[76:79], v[64:67], v[132:135]
    s_waitcnt lgkmcnt(8)
    v_mfma_f32_16x16x32_bf16 v[136:139], v[80:83], v[64:67], v[136:139]
    s_waitcnt lgkmcnt(6)
    v_mfma_f32_16x16x32_bf16 v[140:143], v[84:87], v[64:67], v[140:143]
    s_waitcnt lgkmcnt(4)
    v_mfma_f32_16x16x32_bf16 v[144:147], v[88:91], v[64:67], v[144:147]
    s_waitcnt lgkmcnt(2)
    v_mfma_f32_16x16x32_bf16 v[148:151], v[92:95], v[64:67], v[148:151]
    s_waitcnt lgkmcnt(0)
    v_mfma_f32_16x16x32_bf16 v[152:155], v[96:99], v[64:67], v[152:155]
    ds_read_b128 v[64:67], v37 offset:512
    ds_read_b64_tr_b16 v[72:73], v40 offset:15360
    ds_read_b64_tr_b16 v[74:75], v40 offset:19200
    ds_read_b64_tr_b16 v[76:77], v40 offset:15392
    ds_read_b64_tr_b16 v[78:79], v40 offset:19232
    ds_read_b64_tr_b16 v[80:81], v40 offset:15424
    ds_read_b64_tr_b16 v[82:83], v40 offset:19264
    ds_read_b64_tr_b16 v[84:85], v40 offset:15456
    ds_read_b64_tr_b16 v[86:87], v40 offset:19296
    ds_read_b64_tr_b16 v[88:89], v40 offset:15488
    ds_read_b64_tr_b16 v[90:91], v40 offset:19328
    ds_read_b64_tr_b16 v[92:93], v40 offset:15520
    ds_read_b64_tr_b16 v[94:95], v40 offset:19360
    ds_read_b64_tr_b16 v[96:97], v40 offset:15552
    ds_read_b64_tr_b16 v[98:99], v40 offset:19392
    s_waitcnt lgkmcnt(12)
    v_mfma_f32_16x16x32_bf16 v[128:131], v[72:75], v[64:67], v[128:131]
    s_waitcnt lgkmcnt(10)
    v_mfma_f32_16x16x32_bf16 v[132:135], v[76:79], v[64:67], v[132:135]
    s_waitcnt lgkmcnt(8)
    v_mfma_f32_16x16x32_bf16 v[136:139], v[80:83], v[64:67], v[136:139]
    s_waitcnt lgkmcnt(6)
    v_mfma_f32_16x16x32_bf16 v[140:143], v[84:87], v[64:67], v[140:143]
    s_waitcnt lgkmcnt(4)
    v_mfma_f32_16x16x32_bf16 v[144:147], v[88:91], v[64:67], v[144:147]
    s_waitcnt lgkmcnt(2)
    v_mfma_f32_16x16x32_bf16 v[148:151], v[92:95], v[64:67], v[148:151]
    s_waitcnt lgkmcnt(0)
    v_mfma_f32_16x16x32_bf16 v[152:155], v[96:99], v[64:67], v[152:155]
    s_waitcnt vmcnt(8)
    ds_write_b128 v16, v[100:103] offset:30720
    ds_write_b128 v17, v[104:107] offset:30720
    ds_write_b128 v18, v[108:111] offset:30720
    s_mov_b64 exec, s[46:47]
    ds_write_b128 v19, v[112:115] offset:30720
    s_mov_b64 exec, -1
    s_waitcnt lgkmcnt(0)
    s_barrier
    ds_read_b128 v[64:67], v38 offset:512
    ds_read_b64_tr_b16 v[72:73], v40 offset:30720
    ds_read_b64_tr_b16 v[74:75], v40 offset:34560
    ds_read_b64_tr_b16 v[76:77], v40 offset:30752
    ds_read_b64_tr_b16 v[78:79], v40 offset:34592
    ds_read_b64_tr_b16 v[80:81], v40 offset:30784
    ds_read_b64_tr_b16 v[82:83], v40 offset:34624
    ds_read_b64_tr_b16 v[84:85], v40 offset:30816
    ds_read_b64_tr_b16 v[86:87], v40 offset:34656
    ds_read_b64_tr_b16 v[88:89], v40 offset:30848
    ds_read_b64_tr_b16 v[90:91], v40 offset:34688
    ds_read_b64_tr_b16 v[92:93], v40 offset:30880
    ds_read_b64_tr_b16 v[94:95], v40 offset:34720
    ds_read_b64_tr_b16 v[96:97], v40 offset:30912
    ds_read_b64_tr_b16 v[98:99], v40 offset:34752
    s_waitcnt lgkmcnt(12)
    v_mfma_f32_16x16x32_bf16 v[128:131], v[72:75], v[64:67], v[128:131]
    s_waitcnt lgkmcnt(10)
    v_mfma_f32_16x16x32_bf16 v[132:135], v[76:79], v[64:67], v[132:135]
    s_waitcnt lgkmcnt(8)
    v_mfma_f32_16x16x32_bf16 v[136:139], v[80:83], v[64:67], v[136:139]
    s_waitcnt lgkmcnt(6)
    v_mfma_f32_16x16x32_bf16 v[140:143], v[84:87], v[64:67], v[140:143]
    s_waitcnt lgkmcnt(4)
    v_mfma_f32_16x16x32_bf16 v[144:147], v[88:91], v[64:67], v[144:147]
    s_waitcnt lgkmcnt(2)
    v_mfma_f32_16x16x32_bf16 v[148:151], v[92:95], v[64:67], v[148:151]
    s_waitcnt lgkmcnt(0)
    v_mfma_f32_16x16x32_bf16 v[152:155], v[96:99], v[64:67], v[152:155]
    ds_read_b128 v[64:67], v39 offset:512
    ds_read_b64_tr_b16 v[72:73], v40 offset:46080
    ds_read_b64_tr_b16 v[74:75], v40 offset:49920
    ds_read_b64_tr_b16 v[76:77], v40 offset:46112
    ds_read_b64_tr_b16 v[78:79], v40 offset:49952
    ds_read_b64_tr_b16 v[80:81], v40 offset:46144
    ds_read_b64_tr_b16 v[82:83], v40 offset:49984
    ds_read_b64_tr_b16 v[84:85], v40 offset:46176
    ds_read_b64_tr_b16 v[86:87], v40 offset:50016
    ds_read_b64_tr_b16 v[88:89], v40 offset:46208
    ds_read_b64_tr_b16 v[90:91], v40 offset:50048
    ds_read_b64_tr_b16 v[92:93], v40 offset:46240
    ds_read_b64_tr_b16 v[94:95], v40 offset:50080
    ds_read_b64_tr_b16 v[96:97], v40 offset:46272
    ds_read_b64_tr_b16 v[98:99], v40 offset:50112
    s_waitcnt lgkmcnt(12)
    v_mfma_f32_16x16x32_bf16 v[128:131], v[72:75], v[64:67], v[128:131]
    s_waitcnt lgkmcnt(10)
    v_mfma_f32_16x16x32_bf16 v[132:135], v[76:79], v[64:67], v[132:135]
    s_waitcnt lgkmcnt(8)
    v_mfma_f32_16x16x32_bf16 v[136:139], v[80:83], v[64:67], v[136:139]
    s_waitcnt lgkmcnt(6)
    v_mfma_f32_16x16x32_bf16 v[140:143], v[84:87], v[64:67], v[140:143]
    s_waitcnt lgkmcnt(4)
    v_mfma_f32_16x16x32_bf16 v[144:147], v[88:91], v[64:67], v[144:147]
    s_waitcnt lgkmcnt(2)
    v_mfma_f32_16x16x32_bf16 v[148:151], v[92:95], v[64:67], v[148:151]
    s_waitcnt lgkmcnt(0)
    v_mfma_f32_16x16x32_bf16 v[152:155], v[96:99], v[64:67], v[152:155]
    s_waitcnt vmcnt(4)
    ds_write_b128 v16, v[184:187] offset:0
    ds_write_b128 v17, v[188:191] offset:0
    ds_write_b128 v18, v[192:195] offset:0
    s_mov_b64 exec, s[46:47]
    ds_write_b128 v19, v[196:199] offset:0
    s_mov_b64 exec, -1
    s_waitcnt lgkmcnt(0)
    s_barrier
    ds_read_b128 v[64:67], v36 offset:768
    ds_read_b64_tr_b16 v[72:73], v40 offset:0
    ds_read_b64_tr_b16 v[74:75], v40 offset:3840
    ds_read_b64_tr_b16 v[76:77], v40 offset:32
    ds_read_b64_tr_b16 v[78:79], v40 offset:3872
    ds_read_b64_tr_b16 v[80:81], v40 offset:64
    ds_read_b64_tr_b16 v[82:83], v40 offset:3904
    ds_read_b64_tr_b16 v[84:85], v40 offset:96
    ds_read_b64_tr_b16 v[86:87], v40 offset:3936
    ds_read_b64_tr_b16 v[88:89], v40 offset:128
    ds_read_b64_tr_b16 v[90:91], v40 offset:3968
    ds_read_b64_tr_b16 v[92:93], v40 offset:160
    ds_read_b64_tr_b16 v[94:95], v40 offset:4000
    ds_read_b64_tr_b16 v[96:97], v40 offset:192
    ds_read_b64_tr_b16 v[98:99], v40 offset:4032
    s_waitcnt lgkmcnt(12)
    v_mfma_f32_16x16x32_bf16 v[128:131], v[72:75], v[64:67], v[128:131]
    s_waitcnt lgkmcnt(10)
    v_mfma_f32_16x16x32_bf16 v[132:135], v[76:79], v[64:67], v[132:135]
    s_waitcnt lgkmcnt(8)
    v_mfma_f32_16x16x32_bf16 v[136:139], v[80:83], v[64:67], v[136:139]
    s_waitcnt lgkmcnt(6)
    v_mfma_f32_16x16x32_bf16 v[140:143], v[84:87], v[64:67], v[140:143]
    s_waitcnt lgkmcnt(4)
    v_mfma_f32_16x16x32_bf16 v[144:147], v[88:91], v[64:67], v[144:147]
    s_waitcnt lgkmcnt(2)
    v_mfma_f32_16x16x32_bf16 v[148:151], v[92:95], v[64:67], v[148:151]
    s_waitcnt lgkmcnt(0)
    v_mfma_f32_16x16x32_bf16 v[152:155], v[96:99], v[64:67], v[152:155]
    ds_read_b128 v[64:67], v37 offset:768
    ds_read_b64_tr_b16 v[72:73], v40 offset:15360
    ds_read_b64_tr_b16 v[74:75], v40 offset:19200
    ds_read_b64_tr_b16 v[76:77], v40 offset:15392
    ds_read_b64_tr_b16 v[78:79], v40 offset:19232
    ds_read_b64_tr_b16 v[80:81], v40 offset:15424
    ds_read_b64_tr_b16 v[82:83], v40 offset:19264
    ds_read_b64_tr_b16 v[84:85], v40 offset:15456
    ds_read_b64_tr_b16 v[86:87], v40 offset:19296
    ds_read_b64_tr_b16 v[88:89], v40 offset:15488
    ds_read_b64_tr_b16 v[90:91], v40 offset:19328
    ds_read_b64_tr_b16 v[92:93], v40 offset:15520
    ds_read_b64_tr_b16 v[94:95], v40 offset:19360
    ds_read_b64_tr_b16 v[96:97], v40 offset:15552
    ds_read_b64_tr_b16 v[98:99], v40 offset:19392
    s_waitcnt lgkmcnt(12)
    v_mfma_f32_16x16x32_bf16 v[128:131], v[72:75], v[64:67], v[128:131]
    s_waitcnt lgkmcnt(10)
    v_mfma_f32_16x16x32_bf16 v[132:135], v[76:79], v[64:67], v[132:135]
    s_waitcnt lgkmcnt(8)
    v_mfma_f32_16x16x32_bf16 v[136:139], v[80:83], v[64:67], v[136:139]
    s_waitcnt lgkmcnt(6)
    v_mfma_f32_16x16x32_bf16 v[140:143], v[84:87], v[64:67], v[140:143]
    s_waitcnt lgkmcnt(4)
    v_mfma_f32_16x16x32_bf16 v[144:147], v[88:91], v[64:67], v[144:147]
    s_waitcnt lgkmcnt(2)
    v_mfma_f32_16x16x32_bf16 v[148:151], v[92:95], v[64:67], v[148:151]
    s_waitcnt lgkmcnt(0)
    v_mfma_f32_16x16x32_bf16 v[152:155], v[96:99], v[64:67], v[152:155]
    s_waitcnt vmcnt(0)
    ds_write_b128 v16, v[212:215] offset:30720
    ds_write_b128 v17, v[216:219] offset:30720
    ds_write_b128 v18, v[220:223] offset:30720
    s_mov_b64 exec, s[46:47]
    ds_write_b128 v19, v[224:227] offset:30720
    s_mov_b64 exec, -1
    s_waitcnt lgkmcnt(0)
    s_barrier
    ds_read_b128 v[64:67], v38 offset:768
    ds_read_b64_tr_b16 v[72:73], v40 offset:30720
    ds_read_b64_tr_b16 v[74:75], v40 offset:34560
    ds_read_b64_tr_b16 v[76:77], v40 offset:30752
    ds_read_b64_tr_b16 v[78:79], v40 offset:34592
    ds_read_b64_tr_b16 v[80:81], v40 offset:30784
    ds_read_b64_tr_b16 v[82:83], v40 offset:34624
    ds_read_b64_tr_b16 v[84:85], v40 offset:30816
    ds_read_b64_tr_b16 v[86:87], v40 offset:34656
    ds_read_b64_tr_b16 v[88:89], v40 offset:30848
    ds_read_b64_tr_b16 v[90:91], v40 offset:34688
    ds_read_b64_tr_b16 v[92:93], v40 offset:30880
    ds_read_b64_tr_b16 v[94:95], v40 offset:34720
    ds_read_b64_tr_b16 v[96:97], v40 offset:30912
    ds_read_b64_tr_b16 v[98:99], v40 offset:34752
    s_waitcnt lgkmcnt(12)
    v_mfma_f32_16x16x32_bf16 v[128:131], v[72:75], v[64:67], v[128:131]
    s_waitcnt lgkmcnt(10)
    v_mfma_f32_16x16x32_bf16 v[132:135], v[76:79], v[64:67], v[132:135]
    s_waitcnt lgkmcnt(8)
    v_mfma_f32_16x16x32_bf16 v[136:139], v[80:83], v[64:67], v[136:139]
    s_waitcnt lgkmcnt(6)
    v_mfma_f32_16x16x32_bf16 v[140:143], v[84:87], v[64:67], v[140:143]
    s_waitcnt lgkmcnt(4)
    v_mfma_f32_16x16x32_bf16 v[144:147], v[88:91], v[64:67], v[144:147]
    s_waitcnt lgkmcnt(2)
    v_mfma_f32_16x16x32_bf16 v[148:151], v[92:95], v[64:67], v[148:151]
    s_waitcnt lgkmcnt(0)
    v_mfma_f32_16x16x32_bf16 v[152:155], v[96:99], v[64:67], v[152:155]
    ds_read_b128 v[64:67], v39 offset:768
    ds_read_b64_tr_b16 v[72:73], v40 offset:46080
    ds_read_b64_tr_b16 v[74:75], v40 offset:49920
    ds_read_b64_tr_b16 v[76:77], v40 offset:46112
    ds_read_b64_tr_b16 v[78:79], v40 offset:49952
    ds_read_b64_tr_b16 v[80:81], v40 offset:46144
    ds_read_b64_tr_b16 v[82:83], v40 offset:49984
    ds_read_b64_tr_b16 v[84:85], v40 offset:46176
    ds_read_b64_tr_b16 v[86:87], v40 offset:50016
    ds_read_b64_tr_b16 v[88:89], v40 offset:46208
    ds_read_b64_tr_b16 v[90:91], v40 offset:50048
    ds_read_b64_tr_b16 v[92:93], v40 offset:46240
    ds_read_b64_tr_b16 v[94:95], v40 offset:50080
    ds_read_b64_tr_b16 v[96:97], v40 offset:46272
    ds_read_b64_tr_b16 v[98:99], v40 offset:50112
    s_waitcnt lgkmcnt(12)
    v_mfma_f32_16x16x32_bf16 v[128:131], v[72:75], v[64:67], v[128:131]
    s_waitcnt lgkmcnt(10)
    v_mfma_f32_16x16x32_bf16 v[132:135], v[76:79], v[64:67], v[132:135]
    s_waitcnt lgkmcnt(8)
    v_mfma_f32_16x16x32_bf16 v[136:139], v[80:83], v[64:67], v[136:139]
    s_waitcnt lgkmcnt(6)
    v_mfma_f32_16x16x32_bf16 v[140:143], v[84:87], v[64:67], v[140:143]
    s_waitcnt lgkmcnt(4)
    v_mfma_f32_16x16x32_bf16 v[144:147], v[88:91], v[64:67], v[144:147]
    s_waitcnt lgkmcnt(2)
    v_mfma_f32_16x16x32_bf16 v[148:151], v[92:95], v[64:67], v[148:151]
    s_waitcnt lgkmcnt(0)
    v_mfma_f32_16x16x32_bf16 v[152:155], v[96:99], v[64:67], v[152:155]
    s_cmp_ge_u32 s29, 896
    s_cbranch_scc0 k4_win_kernel_z1
    s_mov_b32 s20, s24
    s_mov_b32 s21, s25
    s_mov_b32 s22, s26
    s_mov_b32 s23, s27
k4_win_kernel_z1:
    s_nop 7
    s_lshr_b32 s37, s30, 1
    s_lshl_b32 s37, s37, 4
    s_add_u32 s37, s37, s28
    s_and_b32 s38, s30, 1
    s_mul_i32 s38, s38, 112
    s_add_u32 s38, s38, s29
    v_add_u32 v5, s37, v4
    s_mov_b32 s34, 1792
    v_mul_u32_u24 v5, s34, v5
    v_lshl_add_u32 v6, v3, 2, s38
    s_cmp_ge_u32 s29, 896
    s_cselect_b32 s39, 896, 0
    v_subrev_u32 v7, s39, v6
    v_lshl_add_u32 v5, v7, 1, v5
    v_cvt_pk_bf16_f32 v128, v128, v128
    v_lshlrev_b32 v128, 16, v128
    v_mul_f32 v32, v128, v128
    v_mul_f32 v32, v128, v32
    v_fma_f32 v32, v32, s40, v128
    v_mul_f32 v32, s41, v32
    v_exp_f32 v32, v32
    s_nop 0
    v_add_f32 v32, 1.0, v32
    v_rcp_f32 v32, v32
    s_nop 0
    v_mul_f32 v128, v128, v32
    v_cvt_pk_bf16_f32 v129, v129, v129
    v_lshlrev_b32 v129, 16, v129
    v_mul_f32 v32, v129, v129
    v_mul_f32 v32, v129, v32
    v_fma_f32 v32, v32, s40, v129
    v_mul_f32 v32, s41, v32
    v_exp_f32 v32, v32
    s_nop 0
    v_add_f32 v32, 1.0, v32
    v_rcp_f32 v32, v32
    s_nop 0
    v_mul_f32 v129, v129, v32
    v_cvt_pk_bf16_f32 v130, v130, v130
    v_lshlrev_b32 v130, 16, v130
    v_mul_f32 v32, v130, v130
    v_mul_f32 v32, v130, v32
    v_fma_f32 v32, v32, s40, v130
    v_mul_f32 v32, s41, v32
    v_exp_f32 v32, v32
    s_nop 0
    v_add_f32 v32, 1.0, v32
    v_rcp_f32 v32, v32
    s_nop 0
    v_mul_f32 v130, v130, v32
    v_cvt_pk_bf16_f32 v131, v131, v131
    v_lshlrev_b32 v131, 16, v131
    v_mul_f32 v32, v131, v131
    v_mul_f32 v32, v131, v32
    v_fma_f32 v32, v32, s40, v131
    v_mul_f32 v32, s41, v32
    v_exp_f32 v32, v32
    s_nop 0
    v_add_f32 v32, 1.0, v32
    v_rcp_f32 v32, v32
    s_nop 0
    v_mul_f32 v131, v131, v32
    v_cvt_pk_bf16_f32 v128, v128, v129
    v_cvt_pk_bf16_f32 v129, v130, v131
    buffer_store_dwordx2 v[128:129], v5, s[20:23], s42 offen offset:0
    v_cvt_pk_bf16_f32 v132, v132, v132
    v_lshlrev_b32 v132, 16, v132
    v_mul_f32 v32, v132, v132
    v_mul_f32 v32, v132, v32
    v_fma_f32 v32, v32, s40, v132
    v_mul_f32 v32, s41, v32
    v_exp_f32 v32, v32
    s_nop 0
    v_add_f32 v32, 1.0, v32
    v_rcp_f32 v32, v32
    s_nop 0
    v_mul_f32 v132, v132, v32
    v_cvt_pk_bf16_f32 v133, v133, v133
    v_lshlrev_b32 v133, 16, v133
    v_mul_f32 v32, v133, v133
    v_mul_f32 v32, v133, v32
    v_fma_f32 v32, v32, s40, v133
    v_mul_f32 v32, s41, v32
    v_exp_f32 v32, v32
    s_nop 0
    v_add_f32 v32, 1.0, v32
    v_rcp_f32 v32, v32
    s_nop 0
    v_mul_f32 v133, v133, v32
    v_cvt_pk_bf16_f32 v134, v134, v134
    v_lshlrev_b32 v134, 16, v134
    v_mul_f32 v32, v134, v134
    v_mul_f32 v32, v134, v32
    v_fma_f32 v32, v32, s40, v134
    v_mul_f32 v32, s41, v32
    v_exp_f32 v32, v32
    s_nop 0
    v_add_f32 v32, 1.0, v32
    v_rcp_f32 v32, v32
    s_nop 0
    v_mul_f32 v134, v134, v32
    v_cvt_pk_bf16_f32 v135, v135, v135
    v_lshlrev_b32 v135, 16, v135
    v_mul_f32 v32, v135, v135
    v_mul_f32 v32, v135, v32
    v_fma_f32 v32, v32, s40, v135
    v_mul_f32 v32, s41, v32
    v_exp_f32 v32, v32
    s_nop 0
    v_add_f32 v32, 1.0, v32
    v_rcp_f32 v32, v32
    s_nop 0
    v_mul_f32 v135, v135, v32
    v_cvt_pk_bf16_f32 v132, v132, v133
    v_cvt_pk_bf16_f32 v133, v134, v135
    buffer_store_dwordx2 v[132:133], v5, s[20:23], s42 offen offset:32
    v_cvt_pk_bf16_f32 v136, v136, v136
    v_lshlrev_b32 v136, 16, v136
    v_mul_f32 v32, v136, v136
    v_mul_f32 v32, v136, v32
    v_fma_f32 v32, v32, s40, v136
    v_mul_f32 v32, s41, v32
    v_exp_f32 v32, v32
    s_nop 0
    v_add_f32 v32, 1.0, v32
    v_rcp_f32 v32, v32
    s_nop 0
    v_mul_f32 v136, v136, v32
    v_cvt_pk_bf16_f32 v137, v137, v137
    v_lshlrev_b32 v137, 16, v137
    v_mul_f32 v32, v137, v137
    v_mul_f32 v32, v137, v32
    v_fma_f32 v32, v32, s40, v137
    v_mul_f32 v32, s41, v32
    v_exp_f32 v32, v32
    s_nop 0
    v_add_f32 v32, 1.0, v32
    v_rcp_f32 v32, v32
    s_nop 0
    v_mul_f32 v137, v137, v32
    v_cvt_pk_bf16_f32 v138, v138, v138
    v_lshlrev_b32 v138, 16, v138
    v_mul_f32 v32, v138, v138
    v_mul_f32 v32, v138, v32
    v_fma_f32 v32, v32, s40, v138
    v_mul_f32 v32, s41, v32
    v_exp_f32 v32, v32
    s_nop 0
    v_add_f32 v32, 1.0, v32
    v_rcp_f32 v32, v32
    s_nop 0
    v_mul_f32 v138, v138, v32
    v_cvt_pk_bf16_f32 v139, v139, v139
    v_lshlrev_b32 v139, 16, v139
    v_mul_f32 v32, v139, v139
    v_mul_f32 v32, v139, v32
    v_fma_f32 v32, v32, s40, v139
    v_mul_f32 v32, s41, v32
    v_exp_f32 v32, v32
    s_nop 0
    v_add_f32 v32, 1.0, v32
    v_rcp_f32 v32, v32
    s_nop 0
    v_mul_f32 v139, v139, v32
    v_cvt_pk_bf16_f32 v136, v136, v137
    v_cvt_pk_bf16_f32 v137, v138, v139
    buffer_store_dwordx2 v[136:137], v5, s[20:23], s42 offen offset:64
    v_cvt_pk_bf16_f32 v140, v140, v140
    v_lshlrev_b32 v140, 16, v140
    v_mul_f32 v32, v140, v140
    v_mul_f32 v32, v140, v32
    v_fma_f32 v32, v32, s40, v140
    v_mul_f32 v32, s41, v32
    v_exp_f32 v32, v32
    s_nop 0
    v_add_f32 v32, 1.0, v32
    v_rcp_f32 v32, v32
    s_nop 0
    v_mul_f32 v140, v140, v32
    v_cvt_pk_bf16_f32 v141, v141, v141
    v_lshlrev_b32 v141, 16, v141
    v_mul_f32 v32, v141, v141
    v_mul_f32 v32, v141, v32
    v_fma_f32 v32, v32, s40, v141
    v_mul_f32 v32, s41, v32
    v_exp_f32 v32, v32
    s_nop 0
    v_add_f32 v32, 1.0, v32
    v_rcp_f32 v32, v32
    s_nop 0
    v_mul_f32 v141, v141, v32
    v_cvt_pk_bf16_f32 v142, v142, v142
    v_lshlrev_b32 v142, 16, v142
    v_mul_f32 v32, v142, v142
    v_mul_f32 v32, v142, v32
    v_fma_f32 v32, v32, s40, v142
    v_mul_f32 v32, s41, v32
    v_exp_f32 v32, v32
    s_nop 0
    v_add_f32 v32, 1.0, v32
    v_rcp_f32 v32, v32
    s_nop 0
    v_mul_f32 v142, v142, v32
    v_cvt_pk_bf16_f32 v143, v143, v143
    v_lshlrev_b32 v143, 16, v143
    v_mul_f32 v32, v143, v143
    v_mul_f32 v32, v143, v32
    v_fma_f32 v32, v32, s40, v143
    v_mul_f32 v32, s41, v32
    v_exp_f32 v32, v32
    s_nop 0
    v_add_f32 v32, 1.0, v32
    v_rcp_f32 v32, v32
    s_nop 0
    v_mul_f32 v143, v143, v32
    v_cvt_pk_bf16_f32 v140, v140, v141
    v_cvt_pk_bf16_f32 v141, v142, v143
    buffer_store_dwordx2 v[140:141], v5, s[20:23], s42 offen offset:96
    v_cvt_pk_bf16_f32 v144, v144, v144
    v_lshlrev_b32 v144, 16, v144
    v_mul_f32 v32, v144, v144
    v_mul_f32 v32, v144, v32
    v_fma_f32 v32, v32, s40, v144
    v_mul_f32 v32, s41, v32
    v_exp_f32 v32, v32
    s_nop 0
    v_add_f32 v32, 1.0, v32
    v_rcp_f32 v32, v32
    s_nop 0
    v_mul_f32 v144, v144, v32
    v_cvt_pk_bf16_f32 v145, v145, v145
    v_lshlrev_b32 v145, 16, v145
    v_mul_f32 v32, v145, v145
    v_mul_f32 v32, v145, v32
    v_fma_f32 v32, v32, s40, v145
    v_mul_f32 v32, s41, v32
    v_exp_f32 v32, v32
    s_nop 0
    v_add_f32 v32, 1.0, v32
    v_rcp_f32 v32, v32
    s_nop 0
    v_mul_f32 v145, v145, v32
    v_cvt_pk_bf16_f32 v146, v146, v146
    v_lshlrev_b32 v146, 16, v146
    v_mul_f32 v32, v146, v146
    v_mul_f32 v32, v146, v32
    v_fma_f32 v32, v32, s40, v146
    v_mul_f32 v32, s41, v32
    v_exp_f32 v32, v32
    s_nop 0
    v_add_f32 v32, 1.0, v32
    v_rcp_f32 v32, v32
    s_nop 0
    v_mul_f32 v146, v146, v32
    v_cvt_pk_bf16_f32 v147, v147, v147
    v_lshlrev_b32 v147, 16, v147
    v_mul_f32 v32, v147, v147
    v_mul_f32 v32, v147, v32
    v_fma_f32 v32, v32, s40, v147
    v_mul_f32 v32, s41, v32
    v_exp_f32 v32, v32
    s_nop 0
    v_add_f32 v32, 1.0, v32
    v_rcp_f32 v32, v32
    s_nop 0
    v_mul_f32 v147, v147, v32
    v_cvt_pk_bf16_f32 v144, v144, v145
    v_cvt_pk_bf16_f32 v145, v146, v147
    buffer_store_dwordx2 v[144:145], v5, s[20:23], s42 offen offset:128
    v_cvt_pk_bf16_f32 v148, v148, v148
    v_lshlrev_b32 v148, 16, v148
    v_mul_f32 v32, v148, v148
    v_mul_f32 v32, v148, v32
    v_fma_f32 v32, v32, s40, v148
    v_mul_f32 v32, s41, v32
    v_exp_f32 v32, v32
    s_nop 0
    v_add_f32 v32, 1.0, v32
    v_rcp_f32 v32, v32
    s_nop 0
    v_mul_f32 v148, v148, v32
    v_cvt_pk_bf16_f32 v149, v149, v149
    v_lshlrev_b32 v149, 16, v149
    v_mul_f32 v32, v149, v149
    v_mul_f32 v32, v149, v32
    v_fma_f32 v32, v32, s40, v149
    v_mul_f32 v32, s41, v32
    v_exp_f32 v32, v32
    s_nop 0
    v_add_f32 v32, 1.0, v32
    v_rcp_f32 v32, v32
    s_nop 0
    v_mul_f32 v149, v149, v32
    v_cvt_pk_bf16_f32 v150, v150, v150
    v_lshlrev_b32 v150, 16, v150
    v_mul_f32 v32, v150, v150
    v_mul_f32 v32, v150, v32
    v_fma_f32 v32, v32, s40, v150
    v_mul_f32 v32, s41, v32
    v_exp_f32 v32, v32
    s_nop 0
    v_add_f32 v32, 1.0, v32
    v_rcp_f32 v32, v32
    s_nop 0
    v_mul_f32 v150, v150, v32
    v_cvt_pk_bf16_f32 v151, v151, v151
    v_lshlrev_b32 v151, 16, v151
    v_mul_f32 v32, v151, v151
    v_mul_f32 v32, v151, v32
    v_fma_f32 v32, v32, s40, v151
    v_mul_f32 v32, s41, v32
    v_exp_f32 v32, v32
    s_nop 0
    v_add_f32 v32, 1.0, v32
    v_rcp_f32 v32, v32
    s_nop 0
    v_mul_f32 v151, v151, v32
    v_cvt_pk_bf16_f32 v148, v148, v149
    v_cvt_pk_bf16_f32 v149, v150, v151
    buffer_store_dwordx2 v[148:149], v5, s[20:23], s42 offen offset:160
    v_cvt_pk_bf16_f32 v152, v152, v152
    v_lshlrev_b32 v152, 16, v152
    v_mul_f32 v32, v152, v152
    v_mul_f32 v32, v152, v32
    v_fma_f32 v32, v32, s40, v152
    v_mul_f32 v32, s41, v32
    v_exp_f32 v32, v32
    s_nop 0
    v_add_f32 v32, 1.0, v32
    v_rcp_f32 v32, v32
    s_nop 0
    v_mul_f32 v152, v152, v32
    v_cvt_pk_bf16_f32 v153, v153, v153
    v_lshlrev_b32 v153, 16, v153
    v_mul_f32 v32, v153, v153
    v_mul_f32 v32, v153, v32
    v_fma_f32 v32, v32, s40, v153
    v_mul_f32 v32, s41, v32
    v_exp_f32 v32, v32
    s_nop 0
    v_add_f32 v32, 1.0, v32
    v_rcp_f32 v32, v32
    s_nop 0
    v_mul_f32 v153, v153, v32
    v_cvt_pk_bf16_f32 v154, v154, v154
    v_lshlrev_b32 v154, 16, v154
    v_mul_f32 v32, v154, v154
    v_mul_f32 v32, v154, v32
    v_fma_f32 v32, v32, s40, v154
    v_mul_f32 v32, s41, v32
    v_exp_f32 v32, v32
    s_nop 0
    v_add_f32 v32, 1.0, v32
    v_rcp_f32 v32, v32
    s_nop 0
    v_mul_f32 v154, v154, v32
    v_cvt_pk_bf16_f32 v155, v155, v155
    v_lshlrev_b32 v155, 16, v155
    v_mul_f32 v32, v155, v155
    v_mul_f32 v32, v155, v32
    v_fma_f32 v32, v32, s40, v155
    v_mul_f32 v32, s41, v32
    v_exp_f32 v32, v32
    s_nop 0
    v_add_f32 v32, 1.0, v32
    v_rcp_f32 v32, v32
    s_nop 0
    v_mul_f32 v155, v155, v32
    v_cvt_pk_bf16_f32 v152, v152, v153
    v_cvt_pk_bf16_f32 v153, v154, v155
    buffer_store_dwordx2 v[152:153], v5, s[20:23], s42 offen offset:192
k4_win_kernel_end:
    s_endpgm
.p2align 8
.globl k5_lnt_kernel
.type k5_lnt_kernel,@function
k5_lnt_kernel:
    s_cmp_ge_u32 s2, 128
    s_cbranch_scc1 k5_lnt_kernel_end
    s_load_dwordx2 s[8:9], s[0:1], 80
    v_and_b32 v1, 63, v0
    v_lshrrev_b32 v2, 6, v0
    s_nop 0
    v_readfirstlane_b32 s30, v2
    s_lshl_b32 s28, s2, 4
    s_waitcnt lgkmcnt(0)
    s_add_u32 s12, s8, 0xe00000
    s_addc_u32 s13, s9, 0
    s_and_b32 s13, s13, 0xffff
    s_mov_b32 s14, 0x380000
    s_mov_b32 s15, 0x00020000
    s_add_u32 s16, s8, 0x1200000
    s_addc_u32 s17, s9, 0
    s_and_b32 s17, s17, 0xffff
    s_mov_b32 s18, 0x380000
    s_mov_b32 s19, 0x00020000
    v_lshrrev_b32 v3, 4, v0
    v_and_b32 v4, 15, v0
    v_add_u32 v5, s28, v3
    s_mov_b32 s34, 1792
    v_mul_u32_u24 v5, s34, v5
    v_lshl_add_u32 v5, v4, 4, v5
    buffer_load_dwordx4 v[32:35], v5, s[12:15], 0 offen offset:0
    buffer_load_dwordx4 v[36:39], v5, s[12:15], 0 offen offset:256
    buffer_load_dwordx4 v[40:43], v5, s[12:15], 0 offen offset:512
    buffer_load_dwordx4 v[44:47], v5, s[12:15], 0 offen offset:768
    buffer_load_dwordx4 v[48:51], v5, s[12:15], 0 offen offset:1024
    buffer_load_dwordx4 v[52:55], v5, s[12:15], 0 offen offset:1280
    buffer_load_dwordx4 v[56:59], v5, s[12:15], 0 offen offset:1536
    s_mov_b32 s36, 0x3f803f80
    v_mov_b32 v24, 0
    v_mov_b32 v25, 0
    v_mov_b32 v26, 0
    v_mov_b32 v27, 0
    s_waitcnt vmcnt(0)
    v_lshlrev_b32 v28, 16, v32
    v_and_b32 v29, 0xffff0000, v32
    v_add_f32 v24, v24, v28
    v_add_f32 v25, v25, v29
    v_fma_f32 v26, v28, v28, v26
    v_fma_f32 v27, v29, v29, v27
    v_lshlrev_b32 v28, 16, v33
    v_and_b32 v29, 0xffff0000, v33
    v_add_f32 v24, v24, v28
    v_add_f32 v25, v25, v29
    v_fma_f32 v26, v28, v28, v26
    v_fma_f32 v27, v29, v29, v27
    v_lshlrev_b32 v28, 16, v34
    v_and_b32 v29, 0xffff0000, v34
    v_add_f32 v24, v24, v28
    v_add_f32 v25, v25, v29
    v_fma_f32 v26, v28, v28, v26
    v_fma_f32 v27, v29, v29, v27
    v_lshlrev_b32 v28, 16, v35
    v_and_b32 v29, 0xffff0000, v35
    v_add_f32 v24, v24, v28
    v_add_f32 v25, v25, v29
    v_fma_f32 v26, v28, v28, v26
    v_fma_f32 v27, v29, v29, v27
    v_lshlrev_b32 v28, 16, v36
    v_and_b32 v29, 0xffff0000, v36
    v_add_f32 v24, v24, v28
    v_add_f32 v25, v25, v29
    v_fma_f32 v26, v28, v28, v26
    v_fma_f32 v27, v29, v29, v27
    v_lshlrev_b32 v28, 16, v37
    v_and_b32 v29, 0xffff0000, v37
    v_add_f32 v24, v24, v28
    v_add_f32 v25, v25, v29
    v_fma_f32 v26, v28, v28, v26
    v_fma_f32 v27, v29, v29, v27
    v_lshlrev_b32 v28, 16, v38
    v_and_b32 v29, 0xffff0000, v38
    v_add_f32 v24, v24, v28
    v_add_f32 v25, v25, v29
    v_fma_f32 v26, v28, v28, v26
    v_fma_f32 v27, v29, v29, v27
    v_lshlrev_b32 v28, 16, v39
    v_and_b32 v29, 0xffff0000, v39
    v_add_f32 v24, v24, v28
    v_add_f32 v25, v25, v29
    v_fma_f32 v26, v28, v28, v26
    v_fma_f32 v27, v29, v29, v27
    v_lshlrev_b32 v28, 16, v40
    v_and_b32 v29, 0xffff0000, v40
    v_add_f32 v24, v24, v28
    v_add_f32 v25, v25, v29
    v_fma_f32 v26, v28, v28, v26
    v_fma_f32 v27, v29, v29, v27
    v_lshlrev_b32 v28, 16, v41
    v_and_b32 v29, 0xffff0000, v41
    v_add_f32 v24, v24, v28
    v_add_f32 v25, v25, v29
    v_fma_f32 v26, v28, v28, v26
    v_fma_f32 v27, v29, v29, v27
    v_lshlrev_b32 v28, 16, v42
    v_and_b32 v29, 0xffff0000, v42
    v_add_f32 v24, v24, v28
    v_add_f32 v25, v25, v29
    v_fma_f32 v26, v28, v28, v26
    v_fma_f32 v27, v29, v29, v27
    v_lshlrev_b32 v28, 16, v43
    v_and_b32 v29, 0xffff0000, v43
    v_add_f32 v24, v24, v28
    v_add_f32 v25, v25, v29
    v_fma_f32 v26, v28, v28, v26
    v_fma_f32 v27, v29, v29, v27
    v_lshlrev_b32 v28, 16, v44
    v_and_b32 v29, 0xffff0000, v44
    v_add_f32 v24, v24, v28
    v_add_f32 v25, v25, v29
    v_fma_f32 v26, v28, v28, v26
    v_fma_f32 v27, v29, v29, v27
    v_lshlrev_b32 v28, 16, v45
    v_and_b32 v29, 0xffff0000, v45
    v_add_f32 v24, v24, v28
    v_add_f32 v25, v25, v29
    v_fma_f32 v26, v28, v28, v26
    v_fma_f32 v27, v29, v29, v27
    v_lshlrev_b32 v28, 16, v46
    v_and_b32 v29, 0xffff0000, v46
    v_add_f32 v24, v24, v28
    v_add_f32 v25, v25, v29
    v_fma_f32 v26, v28, v28, v26
    v_fma_f32 v27, v29, v29, v27
    v_lshlrev_b32 v28, 16, v47
    v_and_b32 v29, 0xffff0000, v47
    v_add_f32 v24, v24, v28
    v_add_f32 v25, v25, v29
    v_fma_f32 v26, v28, v28, v26
    v_fma_f32 v27, v29, v29, v27
    v_lshlrev_b32 v28, 16, v48
    v_and_b32 v29, 0xffff0000, v48
    v_add_f32 v24, v24, v28
    v_add_f32 v25, v25, v29
    v_fma_f32 v26, v28, v28, v26
    v_fma_f32 v27, v29, v29, v27
    v_lshlrev_b32 v28, 16, v49
    v_and_b32 v29, 0xffff0000, v49
    v_add_f32 v24, v24, v28
    v_add_f32 v25, v25, v29
    v_fma_f32 v26, v28, v28, v26
    v_fma_f32 v27, v29, v29, v27
    v_lshlrev_b32 v28, 16, v50
    v_and_b32 v29, 0xffff0000, v50
    v_add_f32 v24, v24, v28
    v_add_f32 v25, v25, v29
    v_fma_f32 v26, v28, v28, v26
    v_fma_f32 v27, v29, v29, v27
    v_lshlrev_b32 v28, 16, v51
    v_and_b32 v29, 0xffff0000, v51
    v_add_f32 v24, v24, v28
    v_add_f32 v25, v25, v29
    v_fma_f32 v26, v28, v28, v26
    v_fma_f32 v27, v29, v29, v27
    v_lshlrev_b32 v28, 16, v52
    v_and_b32 v29, 0xffff0000, v52
    v_add_f32 v24, v24, v28
    v_add_f32 v25, v25, v29
    v_fma_f32 v26, v28, v28, v26
    v_fma_f32 v27, v29, v29, v27
    v_lshlrev_b32 v28, 16, v53
    v_and_b32 v29, 0xffff0000, v53
    v_add_f32 v24, v24, v28
    v_add_f32 v25, v25, v29
    v_fma_f32 v26, v28, v28, v26
    v_fma_f32 v27, v29, v29, v27
    v_lshlrev_b32 v28, 16, v54
    v_and_b32 v29, 0xffff0000, v54
    v_add_f32 v24, v24, v28
    v_add_f32 v25, v25, v29
    v_fma_f32 v26, v28, v28, v26
    v_fma_f32 v27, v29, v29, v27
    v_lshlrev_b32 v28, 16, v55
    v_and_b32 v29, 0xffff0000, v55
    v_add_f32 v24, v24, v28
    v_add_f32 v25, v25, v29
    v_fma_f32 v26, v28, v28, v26
    v_fma_f32 v27, v29, v29, v27
    v_lshlrev_b32 v28, 16, v56
    v_and_b32 v29, 0xffff0000, v56
    v_add_f32 v24, v24, v28
    v_add_f32 v25, v25, v29
    v_fma_f32 v26, v28, v28, v26
    v_fma_f32 v27, v29, v29, v27
    v_lshlrev_b32 v28, 16, v57
    v_and_b32 v29, 0xffff0000, v57
    v_add_f32 v24, v24, v28
    v_add_f32 v25, v25, v29
    v_fma_f32 v26, v28, v28, v26
    v_fma_f32 v27, v29, v29, v27
    v_lshlrev_b32 v28, 16, v58
    v_and_b32 v29, 0xffff0000, v58
    v_add_f32 v24, v24, v28
    v_add_f32 v25, v25, v29
    v_fma_f32 v26, v28, v28, v26
    v_fma_f32 v27, v29, v29, v27
    v_lshlrev_b32 v28, 16, v59
    v_and_b32 v29, 0xffff0000, v59
    v_add_f32 v24, v24, v28
    v_add_f32 v25, v25, v29
    v_fma_f32 v26, v28, v28, v26
    v_fma_f32 v27, v29, v29, v27
    v_add_f32 v24, v24, v25
    v_add_f32 v26, v26, v27
    s_nop 0
    v_add_f32_dpp v24, v24, v24 quad_perm:[1,0,3,2] row_mask:0xf bank_mask:0xf
    v_add_f32_dpp v26, v26, v26 quad_perm:[1,0,3,2] row_mask:0xf bank_mask:0xf
    s_nop 0
    v_add_f32_dpp v24, v24, v24 quad_perm:[2,3,0,1] row_mask:0xf bank_mask:0xf
    v_add_f32_dpp v26, v26, v26 quad_perm:[2,3,0,1] row_mask:0xf bank_mask:0xf
    s_nop 0
    v_add_f32_dpp v24, v24, v24 row_half_mirror row_mask:0xf bank_mask:0xf
    v_add_f32_dpp v26, v26, v26 row_half_mirror row_mask:0xf bank_mask:0xf
    s_nop 0
    v_add_f32_dpp v24, v24, v24 row_mirror row_mask:0xf bank_mask:0xf
    v_add_f32_dpp v26, v26, v26 row_mirror row_mask:0xf bank_mask:0xf
    v_mul_f32 v24, 0x3a924925, v24
    v_mul_f32 v26, 0x3a924925, v26
    v_fma_f32 v26, -v24, v24, v26
    v_max_f32 v26, 0, v26
    v_cvt_pk_bf16_f32 v24, v24, v24
    v_lshlrev_b32 v24, 16, v24
    v_cvt_pk_bf16_f32 v26, v26, v26
    v_lshlrev_b32 v26, 16, v26
    v_add_f32 v26, 0x3727c5ac, v26
    v_cvt_pk_bf16_f32 v26, v26, v26
    v_lshlrev_b32 v26, 16, v26
    v_sqrt_f32 v26, v26
    s_nop 0
    v_cvt_pk_bf16_f32 v26, v26, v26
    v_lshlrev_b32 v26, 16, v26
    v_rcp_f32 v26, v26
    s_nop 0
    v_mul_f32 v24, v24, v26
    v_sub_f32 v24, 0, v24
    s_mov_b32 s34, 1824
    v_mul_u32_u24 v6, s34, v3
    v_lshl_add_u32 v6, v4, 4, v6
    v_lshlrev_b32 v28, 16, v32
    v_and_b32 v29, 0xffff0000, v32
    v_fma_f32 v28, v28, v26, v24
    v_fma_f32 v29, v29, v26, v24
    v_cvt_pk_bf16_f32 v32, v28, v29
    v_lshlrev_b32 v28, 16, v33
    v_and_b32 v29, 0xffff0000, v33
    v_fma_f32 v28, v28, v26, v24
    v_fma_f32 v29, v29, v26, v24
    v_cvt_pk_bf16_f32 v33, v28, v29
    v_lshlrev_b32 v28, 16, v34
    v_and_b32 v29, 0xffff0000, v34
    v_fma_f32 v28, v28, v26, v24
    v_fma_f32 v29, v29, v26, v24
    v_cvt_pk_bf16_f32 v34, v28, v29
    v_lshlrev_b32 v28, 16, v35
    v_and_b32 v29, 0xffff0000, v35
    v_fma_f32 v28, v28, v26, v24
    v_fma_f32 v29, v29, v26, v24
    v_cvt_pk_bf16_f32 v35, v28, v29
    ds_write_b128 v6, v[32:35] offset:0
    v_lshlrev_b32 v28, 16, v36
    v_and_b32 v29, 0xffff0000, v36
    v_fma_f32 v28, v28, v26, v24
    v_fma_f32 v29, v29, v26, v24
    v_cvt_pk_bf16_f32 v36, v28, v29
    v_lshlrev_b32 v28, 16, v37
    v_and_b32 v29, 0xffff0000, v37
    v_fma_f32 v28, v28, v26, v24
    v_fma_f32 v29, v29, v26, v24
    v_cvt_pk_bf16_f32 v37, v28, v29
    v_lshlrev_b32 v28, 16, v38
    v_and_b32 v29, 0xffff0000, v38
    v_fma_f32 v28, v28, v26, v24
    v_fma_f32 v29, v29, v26, v24
    v_cvt_pk_bf16_f32 v38, v28, v29
    v_lshlrev_b32 v28, 16, v39
    v_and_b32 v29, 0xffff0000, v39
    v_fma_f32 v28, v28, v26, v24
    v_fma_f32 v29, v29, v26, v24
    v_cvt_pk_bf16_f32 v39, v28, v29
    ds_write_b128 v6, v[36:39] offset:256
    v_lshlrev_b32 v28, 16, v40
    v_and_b32 v29, 0xffff0000, v40
    v_fma_f32 v28, v28, v26, v24
    v_fma_f32 v29, v29, v26, v24
    v_cvt_pk_bf16_f32 v40, v28, v29
    v_lshlrev_b32 v28, 16, v41
    v_and_b32 v29, 0xffff0000, v41
    v_fma_f32 v28, v28, v26, v24
    v_fma_f32 v29, v29, v26, v24
    v_cvt_pk_bf16_f32 v41, v28, v29
    v_lshlrev_b32 v28, 16, v42
    v_and_b32 v29, 0xffff0000, v42
    v_fma_f32 v28, v28, v26, v24
    v_fma_f32 v29, v29, v26, v24
    v_cvt_pk_bf16_f32 v42, v28, v29
    v_lshlrev_b32 v28, 16, v43
    v_and_b32 v29, 0xffff0000, v43
    v_fma_f32 v28, v28, v26, v24
    v_fma_f32 v29, v29, v26, v24
    v_cvt_pk_bf16_f32 v43, v28, v29
    ds_write_b128 v6, v[40:43] offset:512
    v_lshlrev_b32 v28, 16, v44
    v_and_b32 v29, 0xffff0000, v44
    v_fma_f32 v28, v28, v26, v24
    v_fma_f32 v29, v29, v26, v24
    v_cvt_pk_bf16_f32 v44, v28, v29
    v_lshlrev_b32 v28, 16, v45
    v_and_b32 v29, 0xffff0000, v45
    v_fma_f32 v28, v28, v26, v24
    v_fma_f32 v29, v29, v26, v24
    v_cvt_pk_bf16_f32 v45, v28, v29
    v_lshlrev_b32 v28, 16, v46
    v_and_b32 v29, 0xffff0000, v46
    v_fma_f32 v28, v28, v26, v24
    v_fma_f32 v29, v29, v26, v24
    v_cvt_pk_bf16_f32 v46, v28, v29
    v_lshlrev_b32 v28, 16, v47
    v_and_b32 v29, 0xffff0000, v47
    v_fma_f32 v28, v28, v26, v24
    v_fma_f32 v29, v29, v26, v24
    v_cvt_pk_bf16_f32 v47, v28, v29
    ds_write_b128 v6, v[44:47] offset:768
    v_lshlrev_b32 v28, 16, v48
    v_and_b32 v29, 0xffff0000, v48
    v_fma_f32 v28, v28, v26, v24
    v_fma_f32 v29, v29, v26, v24
    v_cvt_pk_bf16_f32 v48, v28, v29
    v_lshlrev_b32 v28, 16, v49
    v_and_b32 v29, 0xffff0000, v49
    v_fma_f32 v28, v28, v26, v24
    v_fma_f32 v29, v29, v26, v24
    v_cvt_pk_bf16_f32 v49, v28, v29
    v_lshlrev_b32 v28, 16, v50
    v_and_b32 v29, 0xffff0000, v50
    v_fma_f32 v28, v28, v26, v24
    v_fma_f32 v29, v29, v26, v24
    v_cvt_pk_bf16_f32 v50, v28, v29
    v_lshlrev_b32 v28, 16, v51
    v_and_b32 v29, 0xffff0000, v51
    v_fma_f32 v28, v28, v26, v24
    v_fma_f32 v29, v29, v26, v24
    v_cvt_pk_bf16_f32 v51, v28, v29
    ds_write_b128 v6, v[48:51] offset:1024
    v_lshlrev_b32 v28, 16, v52
    v_and_b32 v29, 0xffff0000, v52
    v_fma_f32 v28, v28, v26, v24
    v_fma_f32 v29, v29, v26, v24
    v_cvt_pk_bf16_f32 v52, v28, v29
    v_lshlrev_b32 v28, 16, v53
    v_and_b32 v29, 0xffff0000, v53
    v_fma_f32 v28, v28, v26, v24
    v_fma_f32 v29, v29, v26, v24
    v_cvt_pk_bf16_f32 v53, v28, v29
    v_lshlrev_b32 v28, 16, v54
    v_and_b32 v29, 0xffff0000, v54
    v_fma_f32 v28, v28, v26, v24
    v_fma_f32 v29, v29, v26, v24
    v_cvt_pk_bf16_f32 v54, v28, v29
    v_lshlrev_b32 v28, 16, v55
    v_and_b32 v29, 0xffff0000, v55
    v_fma_f32 v28, v28, v26, v24
    v_fma_f32 v29, v29, v26, v24
    v_cvt_pk_bf16_f32 v55, v28, v29
    ds_write_b128 v6, v[52:55] offset:1280
    v_lshlrev_b32 v28, 16, v56
    v_and_b32 v29, 0xffff0000, v56
    v_fma_f32 v28, v28, v26, v24
    v_fma_f32 v29, v29, v26, v24
    v_cvt_pk_bf16_f32 v56, v28, v29
    v_lshlrev_b32 v28, 16, v57
    v_and_b32 v29, 0xffff0000, v57
    v_fma_f32 v28, v28, v26, v24
    v_fma_f32 v29, v29, v26, v24
    v_cvt_pk_bf16_f32 v57, v28, v29
    v_lshlrev_b32 v28, 16, v58
    v_and_b32 v29, 0xffff0000, v58
    v_fma_f32 v28, v28, v26, v24
    v_fma_f32 v29, v29, v26, v24
    v_cvt_pk_bf16_f32 v58, v28, v29
    v_lshlrev_b32 v28, 16, v59
    v_and_b32 v29, 0xffff0000, v59
    v_fma_f32 v28, v28, v26, v24
    v_fma_f32 v29, v29, v26, v24
    v_cvt_pk_bf16_f32 v59, v28, v29
    ds_write_b128 v6, v[56:59] offset:1536
    s_waitcnt lgkmcnt(0)
    s_barrier
    v_lshrrev_b32 v3, 4, v1
    v_and_b32 v4, 15, v1
    v_lshrrev_b32 v5, 2, v4
    v_lshl_add_u32 v5, v3, 2, v5
    v_mul_u32_u24 v5, s34, v5
    v_and_b32 v6, 3, v4
    v_lshl_add_u32 v5, v6, 3, v5
    s_mul_i32 s37, s30, 448
    v_add_u32 v5, s37, v5
    s_mul_i32 s37, s30, 224
    v_add_u32 v7, s37, v4
    v_lshlrev_b32 v7, 12, v7
    v_lshl_add_u32 v8, v3, 2, s28
    v_lshl_add_u32 v7, v8, 1, v7
    ds_read_b64_tr_b16 v[32:33], v5 offset:0
    ds_read_b64_tr_b16 v[36:37], v5 offset:32
    ds_read_b64_tr_b16 v[40:41], v5 offset:64
    ds_read_b64_tr_b16 v[44:45], v5 offset:96
    ds_read_b64_tr_b16 v[48:49], v5 offset:128
    ds_read_b64_tr_b16 v[52:53], v5 offset:160
    ds_read_b64_tr_b16 v[56:57], v5 offset:192
    ds_read_b64_tr_b16 v[60:61], v5 offset:224
    ds_read_b64_tr_b16 v[64:65], v5 offset:256
    ds_read_b64_tr_b16 v[68:69], v5 offset:288
    ds_read_b64_tr_b16 v[72:73], v5 offset:320
    ds_read_b64_tr_b16 v[76:77], v5 offset:352
    ds_read_b64_tr_b16 v[80:81], v5 offset:384
    ds_read_b64_tr_b16 v[84:85], v5 offset:416
    s_waitcnt lgkmcnt(13)
    s_mov_b32 s38, 0
    buffer_store_dwordx2 v[32:33], v7, s[16:19], s38 offen
    s_waitcnt lgkmcnt(12)
    s_mov_b32 s38, 65536
    buffer_store_dwordx2 v[36:37], v7, s[16:19], s38 offen
    s_waitcnt lgkmcnt(11)
    s_mov_b32 s38, 131072
    buffer_store_dwordx2 v[40:41], v7, s[16:19], s38 offen
    s_waitcnt lgkmcnt(10)
    s_mov_b32 s38, 196608
    buffer_store_dwordx2 v[44:45], v7, s[16:19], s38 offen
    s_waitcnt lgkmcnt(9)
    s_mov_b32 s38, 262144
    buffer_store_dwordx2 v[48:49], v7, s[16:19], s38 offen
    s_waitcnt lgkmcnt(8)
    s_mov_b32 s38, 327680
    buffer_store_dwordx2 v[52:53], v7, s[16:19], s38 offen
    s_waitcnt lgkmcnt(7)
    s_mov_b32 s38, 393216
    buffer_store_dwordx2 v[56:57], v7, s[16:19], s38 offen
    s_waitcnt lgkmcnt(6)
    s_mov_b32 s38, 458752
    buffer_store_dwordx2 v[60:61], v7, s[16:19], s38 offen
    s_waitcnt lgkmcnt(5)
    s_mov_b32 s38, 524288
    buffer_store_dwordx2 v[64:65], v7, s[16:19], s38 offen
    s_waitcnt lgkmcnt(4)
    s_mov_b32 s38, 589824
    buffer_store_dwordx2 v[68:69], v7, s[16:19], s38 offen
    s_waitcnt lgkmcnt(3)
    s_mov_b32 s38, 655360
    buffer_store_dwordx2 v[72:73], v7, s[16:19], s38 offen
    s_waitcnt lgkmcnt(2)
    s_mov_b32 s38, 720896
    buffer_store_dwordx2 v[76:77], v7, s[16:19], s38 offen
    s_waitcnt lgkmcnt(1)
    s_mov_b32 s38, 786432
    buffer_store_dwordx2 v[80:81], v7, s[16:19], s38 offen
    s_waitcnt lgkmcnt(0)
    s_mov_b32 s38, 851968
    buffer_store_dwordx2 v[84:85], v7, s[16:19], s38 offen
k5_lnt_kernel_end:
    s_endpgm
.p2align 8
.globl k6_wsp_kernel
.type k6_wsp_kernel,@function
k6_wsp_kernel:
    s_cmp_ge_u32 s2, 224
    s_cbranch_scc1 k6_wsp_kernel_end
    s_load_dwordx2 s[8:9], s[0:1], 80
    s_load_dwordx2 s[6:7], s[0:1], 40
    s_load_dwordx2 s[4:5], s[0:1], 48
    s_lshr_b32 s31, s2, 3
    s_mul_i32 s28, s31, 9363
    s_lshr_b32 s28, s28, 16
    s_mul_i32 s29, s28, 7
    s_sub_u32 s29, s31, s29
    s_and_b32 s31, s2, 7
    s_lshl_b32 s31, s31, 2
    s_add_u32 s28, s28, s31
    s_lshl_b32 s28, s28, 6
    s_mul_i32 s29, s29, 128
    v_and_b32 v1, 63, v0
    v_lshrrev_b32 v2, 6, v0
    s_nop 0
    v_readfirstlane_b32 s30, v2
    s_waitcnt lgkmcnt(0)
    s_mov_b32 s12, s6
    s_and_b32 s13, s7, 0xffff
    s_mov_b32 s14, 0x800000
    s_mov_b32 s15, 0x00020000
    s_add_u32 s16, s8, 0x1200000
    s_addc_u32 s17, s9, 0
    s_and_b32 s17, s17, 0xffff
    s_mov_b32 s18, 0x380000
    s_mov_b32 s19, 0x00020000
    s_add_u32 s20, s8, 0xa00000
    s_addc_u32 s21, s9, 0
    s_and_b32 s21, s21, 0xffff
    s_mov_b32 s22, 0x380000
    s_mov_b32 s23, 0x00020000
    s_add_u32 s24, s8, 0x1600000
    s_addc_u32 s25, s9, 0
    s_and_b32 s25, s25, 0xffff
    s_mov_b32 s26, 0x380000
    s_mov_b32 s27, 0x00020000
    s_mov_b32 s44, s4
    s_and_b32 s45, s5, 0xffff
    s_mov_b32 s46, 0x1000
    s_mov_b32 s47, 0x00020000
    s_mov_b32 s34, 4096
    s_mov_b32 s35, 4096
    v_add_u32 v3, 0, v0
    v_lshrrev_b32 v4, 3, v3
    v_and_b32 v5, 7, v3
    v_add_u32 v6, s28, v4
    v_mul_u32_u24 v6, s34, v6
    v_lshl_add_u32 v8, v5, 4, v6
    v_and_b32 v6, 7, v4
    v_xor_b32 v6, v6, v5
    v_lshlrev_b32 v6, 4, v6
    v_lshl_add_u32 v10, v4, 7, v6
    v_add_u32 v3, 0, v0
    v_lshrrev_b32 v4, 3, v3
    v_and_b32 v5, 7, v3
    v_add_u32 v6, s29, v4
    v_mul_u32_u24 v6, s35, v6
    v_lshl_add_u32 v12, v5, 4, v6
    v_and_b32 v6, 7, v4
    v_xor_b32 v6, v6, v5
    v_lshlrev_b32 v6, 4, v6
    v_lshl_add_u32 v6, v4, 7, v6
    v_add_u32 v16, 8192, v6
    v_add_u32 v3, 512, v0
    v_lshrrev_b32 v4, 3, v3
    v_and_b32 v5, 7, v3
    v_add_u32 v6, s29, v4
    v_mul_u32_u24 v6, s35, v6
    v_lshl_add_u32 v13, v5, 4, v6
    v_and_b32 v6, 7, v4
    v_xor_b32 v6, v6, v5
    v_lshlrev_b32 v6, 4, v6
    v_lshl_add_u32 v6, v4, 7, v6
    v_add_u32 v17, 8192, v6
    s_mov_b32 s48, 0
    s_mov_b32 s49, 0
    buffer_load_dwordx4 v[64:67], v8, s[12:15], s48 offen
    buffer_load_dwordx4 v[68:71], v12, s[16:19], s49 offen
    buffer_load_dwordx4 v[72:75], v13, s[16:19], s49 offen
    s_add_u32 s48, s48, 128
    s_add_u32 s49, s49, 128
    buffer_load_dwordx4 v[76:79], v8, s[12:15], s48 offen
    buffer_load_dwordx4 v[80:83], v12, s[16:19], s49 offen
    buffer_load_dwordx4 v[84:87], v13, s[16:19], s49 offen
    s_add_u32 s48, s48, 128
    s_add_u32 s49, s49, 128
    buffer_load_dwordx4 v[88:91], v8, s[12:15], s48 offen
    buffer_load_dwordx4 v[92:95], v12, s[16:19], s49 offen
    buffer_load_dwordx4 v[96:99], v13, s[16:19], s49 offen
    s_add_u32 s48, s48, 128
    s_add_u32 s49, s49, 128
    buffer_load_dwordx4 v[100:103], v8, s[12:15], s48 offen
    buffer_load_dwordx4 v[104:107], v12, s[16:19], s49 offen
    buffer_load_dwordx4 v[108:111], v13, s[16:19], s49 offen
    s_add_u32 s48, s48, 128
    s_add_u32 s49, s49, 128
    v_lshrrev_b32 v3, 4, v1
    v_and_b32 v4, 15, v1
    s_lshr_b32 s37, s30, 1
    s_lshl_b32 s37, s37, 11
    v_and_b32 v6, 7, v4
    v_lshlrev_b32 v5, 7, v4
    v_add_u32 v5, s37, v5
    v_add_u32 v20, 0, v3
    v_xor_b32 v20, v20, v6
    v_lshl_add_u32 v20, v20, 4, v5
    v_add_u32 v21, 4, v3
    v_xor_b32 v21, v21, v6
    v_lshl_add_u32 v21, v21, 4, v5
    s_and_b32 s38, s30, 1
    s_mul_i32 s38, s38, 8192
    s_add_u32 s38, s38, 8192
    v_and_b32 v6, 7, v4
    v_lshlrev_b32 v5, 7, v4
    v_add_u32 v5, s38, v5
    v_add_u32 v22, 0, v3
    v_xor_b32 v22, v22, v6
    v_lshl_add_u32 v22, v22, 4, v5
    v_add_u32 v23, 4, v3
    v_xor_b32 v23, v23, v6
    v_lshl_add_u32 v23, v23, 4, v5
    v_mov_b32 v192, 0
    v_mov_b32 v193, 0
    v_mov_b32 v194, 0
    v_mov_b32 v195, 0
    v_mov_b32 v196, 0
    v_mov_b32 v197, 0
    v_mov_b32 v198, 0
    v_mov_b32 v199, 0
    v_mov_b32 v200, 0
    v_mov_b32 v201, 0
    v_mov_b32 v202, 0
    v_mov_b32 v203, 0
    v_mov_b32 v204, 0
    v_mov_b32 v205, 0
    v_mov_b32 v206, 0
    v_mov_b32 v207, 0
    s_waitcnt vmcnt(9)
    ds_write_b128 v10, v[64:67] offset:0
    ds_write_b128 v16, v[68:71] offset:0
    ds_write_b128 v17, v[72:75] offset:0
    buffer_load_dwordx4 v[64:67], v8, s[12:15], s48 offen
    buffer_load_dwordx4 v[68:71], v12, s[16:19], s49 offen
    buffer_load_dwordx4 v[72:75], v13, s[16:19], s49 offen
    s_add_u32 s48, s48, 128
    s_add_u32 s49, s49, 128
    s_waitcnt lgkmcnt(0)
    s_barrier
    s_mov_b32 s50, 8
k6_wsp_kernel_loop:
    ds_read_b128 v[24:27], v20 offset:0
    ds_read_b128 v[32:35], v22 offset:0
    ds_read_b128 v[36:39], v22 offset:2048
    ds_read_b128 v[40:43], v22 offset:4096
    ds_read_b128 v[44:47], v22 offset:6144
    s_waitcnt lgkmcnt(3)
    v_mfma_f32_16x16x32_bf16 v[192:195], v[32:35], v[24:27], v[192:195]
    s_waitcnt lgkmcnt(2)
    v_mfma_f32_16x16x32_bf16 v[196:199], v[36:39], v[24:27], v[196:199]
    s_waitcnt lgkmcnt(1)
    v_mfma_f32_16x16x32_bf16 v[200:203], v[40:43], v[24:27], v[200:203]
    s_waitcnt lgkmcnt(0)
    v_mfma_f32_16x16x32_bf16 v[204:207], v[44:47], v[24:27], v[204:207]
    ds_read_b128 v[24:27], v21 offset:0
    ds_read_b128 v[32:35], v23 offset:0
    ds_read_b128 v[36:39], v23 offset:2048
    ds_read_b128 v[40:43], v23 offset:4096
    ds_read_b128 v[44:47], v23 offset:6144
    s_waitcnt lgkmcnt(3)
    v_mfma_f32_16x16x32_bf16 v[192:195], v[32:35], v[24:27], v[192:195]
    s_waitcnt lgkmcnt(2)
    v_mfma_f32_16x16x32_bf16 v[196:199], v[36:39], v[24:27], v[196:199]
    s_waitcnt lgkmcnt(1)
    v_mfma_f32_16x16x32_bf16 v[200:203], v[40:43], v[24:27], v[200:203]
    s_waitcnt lgkmcnt(0)
    v_mfma_f32_16x16x32_bf16 v[204:207], v[44:47], v[24:27], v[204:207]
    s_waitcnt vmcnt(9)
    ds_write_b128 v10, v[76:79] offset:24576
    ds_write_b128 v16, v[80:83] offset:24576
    ds_write_b128 v17, v[84:87] offset:24576
    buffer_load_dwordx4 v[76:79], v8, s[12:15], s48 offen
    buffer_load_dwordx4 v[80:83], v12, s[16:19], s49 offen
    buffer_load_dwordx4 v[84:87], v13, s[16:19], s49 offen
    s_add_u32 s48, s48, 128
    s_add_u32 s49, s49, 128
    s_waitcnt lgkmcnt(0)
    s_barrier
    ds_read_b128 v[24:27], v20 offset:24576
    ds_read_b128 v[32:35], v22 offset:24576
    ds_read_b128 v[36:39], v22 offset:26624
    ds_read_b128 v[40:43], v22 offset:28672
    ds_read_b128 v[44:47], v22 offset:30720
    s_waitcnt lgkmcnt(3)
    v_mfma_f32_16x16x32_bf16 v[192:195], v[32:35], v[24:27], v[192:195]
    s_waitcnt lgkmcnt(2)
    v_mfma_f32_16x16x32_bf16 v[196:199], v[36:39], v[24:27], v[196:199]
    s_waitcnt lgkmcnt(1)
    v_mfma_f32_16x16x32_bf16 v[200:203], v[40:43], v[24:27], v[200:203]
    s_waitcnt lgkmcnt(0)
    v_mfma_f32_16x16x32_bf16 v[204:207], v[44:47], v[24:27], v[204:207]
    ds_read_b128 v[24:27], v21 offset:24576
    ds_read_b128 v[32:35], v23 offset:24576
    ds_read_b128 v[36:39], v23 offset:26624
    ds_read_b128 v[40:43], v23 offset:28672
    ds_read_b128 v[44:47], v23 offset:30720
    s_waitcnt lgkmcnt(3)
    v_mfma_f32_16x16x32_bf16 v[192:195], v[32:35], v[24:27], v[192:195]
    s_waitcnt lgkmcnt(2)
    v_mfma_f32_16x16x32_bf16 v[196:199], v[36:39], v[24:27], v[196:199]
    s_waitcnt lgkmcnt(1)
    v_mfma_f32_16x16x32_bf16 v[200:203], v[40:43], v[24:27], v[200:203]
    s_waitcnt lgkmcnt(0)
    v_mfma_f32_16x16x32_bf16 v[204:207], v[44:47], v[24:27], v[204:207]
    s_waitcnt vmcnt(9)
    ds_write_b128 v10, v[88:91] offset:0
    ds_write_b128 v16, v[92:95] offset:0
    ds_write_b128 v17, v[96:99] offset:0
    buffer_load_dwordx4 v[88:91], v8, s[12:15], s48 offen
    buffer_load_dwordx4 v[92:95], v12, s[16:19], s49 offen
    buffer_load_dwordx4 v[96:99], v13, s[16:19], s49 offen
    s_add_u32 s48, s48, 128
    s_add_u32 s49, s49, 128
    s_waitcnt lgkmcnt(0)
    s_barrier
    ds_read_b128 v[24:27], v20 offset:0
    ds_read_b128 v[32:35], v22 offset:0
    ds_read_b128 v[36:39], v22 offset:2048
    ds_read_b128 v[40:43], v22 offset:4096
    ds_read_b128 v[44:47], v22 offset:6144
    s_waitcnt lgkmcnt(3)
    v_mfma_f32_16x16x32_bf16 v[192:195], v[32:35], v[24:27], v[192:195]
    s_waitcnt lgkmcnt(2)
    v_mfma_f32_16x16x32_bf16 v[196:199], v[36:39], v[24:27], v[196:199]
    s_waitcnt lgkmcnt(1)
    v_mfma_f32_16x16x32_bf16 v[200:203], v[40:43], v[24:27], v[200:203]
    s_waitcnt lgkmcnt(0)
    v_mfma_f32_16x16x32_bf16 v[204:207], v[44:47], v[24:27], v[204:207]
    ds_read_b128 v[24:27], v21 offset:0
    ds_read_b128 v[32:35], v23 offset:0
    ds_read_b128 v[36:39], v23 offset:2048
    ds_read_b128 v[40:43], v23 offset:4096
    ds_read_b128 v[44:47], v23 offset:6144
    s_waitcnt lgkmcnt(3)
    v_mfma_f32_16x16x32_bf16 v[192:195], v[32:35], v[24:27], v[192:195]
    s_waitcnt lgkmcnt(2)
    v_mfma_f32_16x16x32_bf16 v[196:199], v[36:39], v[24:27], v[196:199]
    s_waitcnt lgkmcnt(1)
    v_mfma_f32_16x16x32_bf16 v[200:203], v[40:43], v[24:27], v[200:203]
    s_waitcnt lgkmcnt(0)
    v_mfma_f32_16x16x32_bf16 v[204:207], v[44:47], v[24:27], v[204:207]
    s_waitcnt vmcnt(9)
    ds_write_b128 v10, v[100:103] offset:24576
    ds_write_b128 v16, v[104:107] offset:24576
    ds_write_b128 v17, v[108:111] offset:24576
    buffer_load_dwordx4 v[100:103], v8, s[12:15], s48 offen
    buffer_load_dwordx4 v[104:107], v12, s[16:19], s49 offen
    buffer_load_dwordx4 v[108:111], v13, s[16:19], s49 offen
    s_add_u32 s48, s48, 128
    s_add_u32 s49, s49, 128
    s_waitcnt lgkmcnt(0)
    s_barrier
    ds_read_b128 v[24:27], v20 offset:24576
    ds_read_b128 v[32:35], v22 offset:24576
    ds_read_b128 v[36:39], v22 offset:26624
    ds_read_b128 v[40:43], v22 offset:28672
    ds_read_b128 v[44:47], v22 offset:30720
    s_waitcnt lgkmcnt(3)
    v_mfma_f32_16x16x32_bf16 v[192:195], v[32:35], v[24:27], v[192:195]
    s_waitcnt lgkmcnt(2)
    v_mfma_f32_16x16x32_bf16 v[196:199], v[36:39], v[24:27], v[196:199]
    s_waitcnt lgkmcnt(1)
    v_mfma_f32_16x16x32_bf16 v[200:203], v[40:43], v[24:27], v[200:203]
    s_waitcnt lgkmcnt(0)
    v_mfma_f32_16x16x32_bf16 v[204:207], v[44:47], v[24:27], v[204:207]
    ds_read_b128 v[24:27], v21 offset:24576
    ds_read_b128 v[32:35], v23 offset:24576
    ds_read_b128 v[36:39], v23 offset:26624
    ds_read_b128 v[40:43], v23 offset:28672
    ds_read_b128 v[44:47], v23 offset:30720
    s_waitcnt lgkmcnt(3)
    v_mfma_f32_16x16x32_bf16 v[192:195], v[32:35], v[24:27], v[192:195]
    s_waitcnt lgkmcnt(2)
    v_mfma_f32_16x16x32_bf16 v[196:199], v[36:39], v[24:27], v[196:199]
    s_waitcnt lgkmcnt(1)
    v_mfma_f32_16x16x32_bf16 v[200:203], v[40:43], v[24:27], v[200:203]
    s_waitcnt lgkmcnt(0)
    v_mfma_f32_16x16x32_bf16 v[204:207], v[44:47], v[24:27], v[204:207]
    s_waitcnt vmcnt(9)
    ds_write_b128 v10, v[64:67] offset:0
    ds_write_b128 v16, v[68:71] offset:0
    ds_write_b128 v17, v[72:75] offset:0
    buffer_load_dwordx4 v[64:67], v8, s[12:15], s48 offen
    buffer_load_dwordx4 v[68:71], v12, s[16:19], s49 offen
    buffer_load_dwordx4 v[72:75], v13, s[16:19], s49 offen
    s_add_u32 s48, s48, 128
    s_add_u32 s49, s49, 128
    s_waitcnt lgkmcnt(0)
    s_barrier
    s_sub_u32 s50, s50, 1
    s_cmp_lg_u32 s50, 0
    s_cbranch_scc1 k6_wsp_kernel_loop
    s_nop 7
    s_lshr_b32 s37, s30, 1
    s_lshl_b32 s37, s37, 4
    s_add_u32 s37, s37, s28
    s_and_b32 s38, s30, 1
    s_mul_i32 s38, s38, 64
    s_add_u32 s38, s38, s29
    v_add_u32 v7, s37, v4
    s_mov_b32 s34, 1792
    v_mul_u32_u24 v5, s34, v7
    v_lshl_add_u32 v6, v3, 2, s38
    v_lshl_add_u32 v5, v6, 1, v5
    s_mov_b32 s42, 0
    s_mov_b32 s43, 28672
    s_waitcnt vmcnt(0)
    buffer_load_dwordx2 v[64:65], v5, s[20:23], s42 offen offset:0
    buffer_load_dwordx2 v[66:67], v5, s[20:23], s42 offen offset:32
    buffer_load_dwordx2 v[68:69], v5, s[20:23], s42 offen offset:64
    buffer_load_dwordx2 v[70:71], v5, s[20:23], s42 offen offset:96
    v_lshlrev_b32 v7, 1, v7
    buffer_load_ushort v120, v7, s[44:47], 0 offen
    buffer_load_ushort v121, v7, s[44:47], 0 offen offset:32
    s_waitcnt vmcnt(0)
    v_lshlrev_b32 v120, 16, v120
    v_lshlrev_b32 v121, 16, v121
    v_cvt_pk_bf16_f32 v192, v192, v193
    v_cvt_pk_bf16_f32 v194, v194, v195
    v_and_b32 v193, 0xffff0000, v192
    v_lshlrev_b32 v192, 16, v192
    v_and_b32 v25, 0xffff0000, v64
    v_lshlrev_b32 v24, 16, v64
    v_add_f32 v192, v192, v120
    v_add_f32 v193, v193, v120
    v_cvt_pk_bf16_f32 v26, v192, v193
    v_and_b32 v193, 0xffff0000, v26
    v_lshlrev_b32 v192, 16, v26
    v_mul_f32 v192, v192, v24
    v_mul_f32 v193, v193, v25
    v_cvt_pk_bf16_f32 v64, v192, v193
    v_and_b32 v195, 0xffff0000, v194
    v_lshlrev_b32 v194, 16, v194
    v_and_b32 v25, 0xffff0000, v65
    v_lshlrev_b32 v24, 16, v65
    v_add_f32 v194, v194, v120
    v_add_f32 v195, v195, v120
    v_cvt_pk_bf16_f32 v26, v194, v195
    v_and_b32 v195, 0xffff0000, v26
    v_lshlrev_b32 v194, 16, v26
    v_mul_f32 v194, v194, v24
    v_mul_f32 v195, v195, v25
    v_cvt_pk_bf16_f32 v65, v194, v195
    buffer_store_dwordx2 v[64:65], v5, s[24:27], s42 offen offset:0
    v_cvt_pk_bf16_f32 v196, v196, v197
    v_cvt_pk_bf16_f32 v198, v198, v199
    v_and_b32 v197, 0xffff0000, v196
    v_lshlrev_b32 v196, 16, v196
    v_and_b32 v25, 0xffff0000, v66
    v_lshlrev_b32 v24, 16, v66
    v_add_f32 v196, v196, v120
    v_add_f32 v197, v197, v120
    v_cvt_pk_bf16_f32 v26, v196, v197
    v_and_b32 v197, 0xffff0000, v26
    v_lshlrev_b32 v196, 16, v26
    v_mul_f32 v196, v196, v24
    v_mul_f32 v197, v197, v25
    v_cvt_pk_bf16_f32 v66, v196, v197
    v_and_b32 v199, 0xffff0000, v198
    v_lshlrev_b32 v198, 16, v198
    v_and_b32 v25, 0xffff0000, v67
    v_lshlrev_b32 v24, 16, v67
    v_add_f32 v198, v198, v120
    v_add_f32 v199, v199, v120
    v_cvt_pk_bf16_f32 v26, v198, v199
    v_and_b32 v199, 0xffff0000, v26
    v_lshlrev_b32 v198, 16, v26
    v_mul_f32 v198, v198, v24
    v_mul_f32 v199, v199, v25
    v_cvt_pk_bf16_f32 v67, v198, v199
    buffer_store_dwordx2 v[66:67], v5, s[24:27], s42 offen offset:32
    v_cvt_pk_bf16_f32 v200, v200, v201
    v_cvt_pk_bf16_f32 v202, v202, v203
    v_and_b32 v201, 0xffff0000, v200
    v_lshlrev_b32 v200, 16, v200
    v_and_b32 v25, 0xffff0000, v68
    v_lshlrev_b32 v24, 16, v68
    v_add_f32 v200, v200, v120
    v_add_f32 v201, v201, v120
    v_cvt_pk_bf16_f32 v26, v200, v201
    v_and_b32 v201, 0xffff0000, v26
    v_lshlrev_b32 v200, 16, v26
    v_mul_f32 v200, v200, v24
    v_mul_f32 v201, v201, v25
    v_cvt_pk_bf16_f32 v68, v200, v201
    v_and_b32 v203, 0xffff0000, v202
    v_lshlrev_b32 v202, 16, v202
    v_and_b32 v25, 0xffff0000, v69
    v_lshlrev_b32 v24, 16, v69
    v_add_f32 v202, v202, v120
    v_add_f32 v203, v203, v120
    v_cvt_pk_bf16_f32 v26, v202, v203
    v_and_b32 v203, 0xffff0000, v26
    v_lshlrev_b32 v202, 16, v26
    v_mul_f32 v202, v202, v24
    v_mul_f32 v203, v203, v25
    v_cvt_pk_bf16_f32 v69, v202, v203
    buffer_store_dwordx2 v[68:69], v5, s[24:27], s42 offen offset:64
    v_cvt_pk_bf16_f32 v204, v204, v205
    v_cvt_pk_bf16_f32 v206, v206, v207
    v_and_b32 v205, 0xffff0000, v204
    v_lshlrev_b32 v204, 16, v204
    v_and_b32 v25, 0xffff0000, v70
    v_lshlrev_b32 v24, 16, v70
    v_add_f32 v204, v204, v120
    v_add_f32 v205, v205, v120
    v_cvt_pk_bf16_f32 v26, v204, v205
    v_and_b32 v205, 0xffff0000, v26
    v_lshlrev_b32 v204, 16, v26
    v_mul_f32 v204, v204, v24
    v_mul_f32 v205, v205, v25
    v_cvt_pk_bf16_f32 v70, v204, v205
    v_and_b32 v207, 0xffff0000, v206
    v_lshlrev_b32 v206, 16, v206
    v_and_b32 v25, 0xffff0000, v71
    v_lshlrev_b32 v24, 16, v71
    v_add_f32 v206, v206, v120
    v_add_f32 v207, v207, v120
    v_cvt_pk_bf16_f32 v26, v206, v207
    v_and_b32 v207, 0xffff0000, v26
    v_lshlrev_b32 v206, 16, v26
    v_mul_f32 v206, v206, v24
    v_mul_f32 v207, v207, v25
    v_cvt_pk_bf16_f32 v71, v206, v207
    buffer_store_dwordx2 v[70:71], v5, s[24:27], s42 offen offset:96
k6_wsp_kernel_end:
    s_endpgm
.p2align 8
.globl k7_wout_kernel
.type k7_wout_kernel,@function
k7_wout_kernel:
    s_cmp_ge_u32 s2, 256
    s_cbranch_scc1 k7_wout_kernel_end
    s_load_dwordx2 s[8:9], s[0:1], 80
    s_load_dwordx2 s[6:7], s[0:1], 56
    s_load_dwordx2 s[4:5], s[0:1], 64
    s_mul_i32 s28, s2, 8193
    s_lshr_b32 s28, s28, 16
    s_mul_i32 s29, s28, 8
    s_sub_u32 s29, s2, s29
    s_lshl_b32 s28, s28, 6
    s_mul_i32 s29, s29, 64
    v_and_b32 v1, 63, v0
    v_lshrrev_b32 v2, 6, v0
    s_nop 0
    v_readfirstlane_b32 s30, v2
    s_waitcnt lgkmcnt(0)
    s_add_u32 s12, s8, 0x1600000
    s_addc_u32 s13, s9, 0
    s_and_b32 s13, s13, 0xffff
    s_mov_b32 s14, 0x380000
    s_mov_b32 s15, 0x00020000
    s_mov_b32 s16, s6
    s_and_b32 s17, s7, 0xffff
    s_mov_b32 s18, 0xe0000
    s_mov_b32 s19, 0x00020000
    s_add_u32 s20, s8, 0x800000
    s_addc_u32 s21, s9, 0
    s_and_b32 s21, s21, 0xffff
    s_mov_b32 s22, 0x200000
    s_mov_b32 s23, 0x00020000
    s_mov_b32 s24, s4
    s_and_b32 s25, s5, 0xffff
    s_mov_b32 s26, 0x200000
    s_mov_b32 s27, 0x00020000
    s_mov_b32 s34, 1792
    s_mov_b32 s35, 1024
    v_add_u32 v3, 0, v0
    v_lshrrev_b32 v4, 3, v3
    v_and_b32 v5, 7, v3
    v_add_u32 v6, s28, v4
    v_mul_u32_u24 v6, s34, v6
    v_lshl_add_u32 v8, v5, 4, v6
    v_and_b32 v6, 7, v4
    v_xor_b32 v6, v6, v5
    v_lshlrev_b32 v6, 4, v6
    v_lshl_add_u32 v10, v4, 7, v6
    v_add_u32 v3, 0, v0
    v_lshrrev_b32 v4, 3, v3
    v_and_b32 v5, 7, v3
    v_mul_u32_u24 v6, s35, v4
    s_lshl_b32 s36, s29, 1
    v_lshl_add_u32 v6, v5, 4, v6
    v_add_u32 v12, s36, v6
    v_bfe_u32 v6, v4, 2, 1
    v_bfe_u32 v7, v4, 3, 1
    v_and_b32 v4, 0xfffffff3, v4
    v_lshl_or_b32 v4, v6, 3, v4
    v_lshl_or_b32 v4, v7, 2, v4
    s_mov_b32 s37, 160
    v_mul_u32_u24 v6, s37, v4
    v_lshl_add_u32 v6, v5, 4, v6
    v_add_u32 v16, 8192, v6
    s_mov_b32 s48, 0
    s_mov_b32 s49, 0
    buffer_load_dwordx4 v[64:67], v8, s[12:15], s48 offen
    buffer_load_dwordx4 v[68:71], v12, s[16:19], s49 offen
    s_add_u32 s48, s48, 128
    s_add_u32 s49, s49, 65536
    buffer_load_dwordx4 v[72:75], v8, s[12:15], s48 offen
    buffer_load_dwordx4 v[76:79], v12, s[16:19], s49 offen
    s_add_u32 s48, s48, 128
    s_add_u32 s49, s49, 65536
    buffer_load_dwordx4 v[80:83], v8, s[12:15], s48 offen
    buffer_load_dwordx4 v[84:87], v12, s[16:19], s49 offen
    s_add_u32 s48, s48, 128
    s_add_u32 s49, s49, 65536
    buffer_load_dwordx4 v[88:91], v8, s[12:15], s48 offen
    buffer_load_dwordx4 v[92:95], v12, s[16:19], s49 offen
    s_add_u32 s48, s48, 128
    s_add_u32 s49, s49, 65536
    v_lshrrev_b32 v3, 4, v1
    v_and_b32 v4, 15, v1
    s_lshr_b32 s37, s30, 1
    s_lshl_b32 s37, s37, 11
    v_and_b32 v6, 7, v4
    v_lshlrev_b32 v5, 7, v4
    v_add_u32 v5, s37, v5
    v_add_u32 v20, 0, v3
    v_xor_b32 v20, v20, v6
    v_lshl_add_u32 v20, v20, 4, v5
    v_add_u32 v21, 4, v3
    v_xor_b32 v21, v21, v6
    v_lshl_add_u32 v21, v21, 4, v5
    v_lshrrev_b32 v5, 1, v3
    v_lshlrev_b32 v5, 4, v5
    v_and_b32 v6, 1, v3
    v_lshl_add_u32 v5, v6, 2, v5
    v_lshrrev_b32 v6, 2, v4
    v_add_u32 v5, v5, v6
    s_mov_b32 s37, 160
    v_mul_u32_u24 v5, s37, v5
    v_and_b32 v6, 3, v4
    v_lshl_add_u32 v5, v6, 3, v5
    s_and_b32 s38, s30, 1
    s_mul_i32 s38, s38, 64
    s_add_u32 s38, s38, 8192
    v_add_u32 v22, s38, v5
    v_mov_b32 v192, 0
    v_mov_b32 v193, 0
    v_mov_b32 v194, 0
    v_mov_b32 v195, 0
    v_mov_b32 v196, 0
    v_mov_b32 v197, 0
    v_mov_b32 v198, 0
    v_mov_b32 v199, 0
    s_waitcnt vmcnt(6)
    ds_write_b128 v10, v[64:67] offset:0
    ds_write_b128 v16, v[68:71] offset:0
    buffer_load_dwordx4 v[64:67], v8, s[12:15], s48 offen
    buffer_load_dwordx4 v[68:71], v12, s[16:19], s49 offen
    s_add_u32 s48, s48, 128
    s_add_u32 s49, s49, 65536
    s_waitcnt lgkmcnt(0)
    s_barrier
    s_mov_b32 s50, 1
k7_wout_kernel_loop:
    ds_read_b128 v[24:27], v20 offset:0
    ds_read_b64_tr_b16 v[32:33], v22 offset:0
    ds_read_b64_tr_b16 v[34:35], v22 offset:1280
    ds_read_b64_tr_b16 v[36:37], v22 offset:32
    ds_read_b64_tr_b16 v[38:39], v22 offset:1312
    s_waitcnt lgkmcnt(2)
    v_mfma_f32_16x16x32_bf16 v[192:195], v[32:35], v[24:27], v[192:195]
    s_waitcnt lgkmcnt(0)
    v_mfma_f32_16x16x32_bf16 v[196:199], v[36:39], v[24:27], v[196:199]
    ds_read_b128 v[24:27], v21 offset:0
    ds_read_b64_tr_b16 v[32:33], v22 offset:5120
    ds_read_b64_tr_b16 v[34:35], v22 offset:6400
    ds_read_b64_tr_b16 v[36:37], v22 offset:5152
    ds_read_b64_tr_b16 v[38:39], v22 offset:6432
    s_waitcnt lgkmcnt(2)
    v_mfma_f32_16x16x32_bf16 v[192:195], v[32:35], v[24:27], v[192:195]
    s_waitcnt lgkmcnt(0)
    v_mfma_f32_16x16x32_bf16 v[196:199], v[36:39], v[24:27], v[196:199]
    s_waitcnt vmcnt(6)
    ds_write_b128 v10, v[72:75] offset:18432
    ds_write_b128 v16, v[76:79] offset:18432
    buffer_load_dwordx4 v[72:75], v8, s[12:15], s48 offen
    buffer_load_dwordx4 v[76:79], v12, s[16:19], s49 offen
    s_add_u32 s48, s48, 128
    s_add_u32 s49, s49, 65536
    s_waitcnt lgkmcnt(0)
    s_barrier
    ds_read_b128 v[24:27], v20 offset:18432
    ds_read_b64_tr_b16 v[32:33], v22 offset:18432
    ds_read_b64_tr_b16 v[34:35], v22 offset:19712
    ds_read_b64_tr_b16 v[36:37], v22 offset:18464
    ds_read_b64_tr_b16 v[38:39], v22 offset:19744
    s_waitcnt lgkmcnt(2)
    v_mfma_f32_16x16x32_bf16 v[192:195], v[32:35], v[24:27], v[192:195]
    s_waitcnt lgkmcnt(0)
    v_mfma_f32_16x16x32_bf16 v[196:199], v[36:39], v[24:27], v[196:199]
    ds_read_b128 v[24:27], v21 offset:18432
    ds_read_b64_tr_b16 v[32:33], v22 offset:23552
    ds_read_b64_tr_b16 v[34:35], v22 offset:24832
    ds_read_b64_tr_b16 v[36:37], v22 offset:23584
    ds_read_b64_tr_b16 v[38:39], v22 offset:24864
    s_waitcnt lgkmcnt(2)
    v_mfma_f32_16x16x32_bf16 v[192:195], v[32:35], v[24:27], v[192:195]
    s_waitcnt lgkmcnt(0)
    v_mfma_f32_16x16x32_bf16 v[196:199], v[36:39], v[24:27], v[196:199]
    s_waitcnt vmcnt(6)
    ds_write_b128 v10, v[80:83] offset:0
    ds_write_b128 v16, v[84:87] offset:0
    buffer_load_dwordx4 v[80:83], v8, s[12:15], s48 offen
    buffer_load_dwordx4 v[84:87], v12, s[16:19], s49 offen
    s_add_u32 s48, s48, 128
    s_add_u32 s49, s49, 65536
    s_waitcnt lgkmcnt(0)
    s_barrier
    ds_read_b128 v[24:27], v20 offset:0
    ds_read_b64_tr_b16 v[32:33], v22 offset:0
    ds_read_b64_tr_b16 v[34:35], v22 offset:1280
    ds_read_b64_tr_b16 v[36:37], v22 offset:32
    ds_read_b64_tr_b16 v[38:39], v22 offset:1312
    s_waitcnt lgkmcnt(2)
    v_mfma_f32_16x16x32_bf16 v[192:195], v[32:35], v[24:27], v[192:195]
    s_waitcnt lgkmcnt(0)
    v_mfma_f32_16x16x32_bf16 v[196:199], v[36:39], v[24:27], v[196:199]
    ds_read_b128 v[24:27], v21 offset:0
    ds_read_b64_tr_b16 v[32:33], v22 offset:5120
    ds_read_b64_tr_b16 v[34:35], v22 offset:6400
    ds_read_b64_tr_b16 v[36:37], v22 offset:5152
    ds_read_b64_tr_b16 v[38:39], v22 offset:6432
    s_waitcnt lgkmcnt(2)
    v_mfma_f32_16x16x32_bf16 v[192:195], v[32:35], v[24:27], v[192:195]
    s_waitcnt lgkmcnt(0)
    v_mfma_f32_16x16x32_bf16 v[196:199], v[36:39], v[24:27], v[196:199]
    s_waitcnt vmcnt(6)
    ds_write_b128 v10, v[88:91] offset:18432
    ds_write_b128 v16, v[92:95] offset:18432
    buffer_load_dwordx4 v[88:91], v8, s[12:15], s48 offen
    buffer_load_dwordx4 v[92:95], v12, s[16:19], s49 offen
    s_add_u32 s48, s48, 128
    s_add_u32 s49, s49, 65536
    s_waitcnt lgkmcnt(0)
    s_barrier
    ds_read_b128 v[24:27], v20 offset:18432
    ds_read_b64_tr_b16 v[32:33], v22 offset:18432
    ds_read_b64_tr_b16 v[34:35], v22 offset:19712
    ds_read_b64_tr_b16 v[36:37], v22 offset:18464
    ds_read_b64_tr_b16 v[38:39], v22 offset:19744
    s_waitcnt lgkmcnt(2)
    v_mfma_f32_16x16x32_bf16 v[192:195], v[32:35], v[24:27], v[192:195]
    s_waitcnt lgkmcnt(0)
    v_mfma_f32_16x16x32_bf16 v[196:199], v[36:39], v[24:27], v[196:199]
    ds_read_b128 v[24:27], v21 offset:18432
    ds_read_b64_tr_b16 v[32:33], v22 offset:23552
    ds_read_b64_tr_b16 v[34:35], v22 offset:24832
    ds_read_b64_tr_b16 v[36:37], v22 offset:23584
    ds_read_b64_tr_b16 v[38:39], v22 offset:24864
    s_waitcnt lgkmcnt(2)
    v_mfma_f32_16x16x32_bf16 v[192:195], v[32:35], v[24:27], v[192:195]
    s_waitcnt lgkmcnt(0)
    v_mfma_f32_16x16x32_bf16 v[196:199], v[36:39], v[24:27], v[196:199]
    s_waitcnt vmcnt(6)
    ds_write_b128 v10, v[64:67] offset:0
    ds_write_b128 v16, v[68:71] offset:0
    buffer_load_dwordx4 v[64:67], v8, s[12:15], s48 offen
    buffer_load_dwordx4 v[68:71], v12, s[16:19], s49 offen
    s_add_u32 s48, s48, 128
    s_add_u32 s49, s49, 65536
    s_waitcnt lgkmcnt(0)
    s_barrier
    ds_read_b128 v[24:27], v20 offset:0
    ds_read_b64_tr_b16 v[32:33], v22 offset:0
    ds_read_b64_tr_b16 v[34:35], v22 offset:1280
    ds_read_b64_tr_b16 v[36:37], v22 offset:32
    ds_read_b64_tr_b16 v[38:39], v22 offset:1312
    s_waitcnt lgkmcnt(2)
    v_mfma_f32_16x16x32_bf16 v[192:195], v[32:35], v[24:27], v[192:195]
    s_waitcnt lgkmcnt(0)
    v_mfma_f32_16x16x32_bf16 v[196:199], v[36:39], v[24:27], v[196:199]
    ds_read_b128 v[24:27], v21 offset:0
    ds_read_b64_tr_b16 v[32:33], v22 offset:5120
    ds_read_b64_tr_b16 v[34:35], v22 offset:6400
    ds_read_b64_tr_b16 v[36:37], v22 offset:5152
    ds_read_b64_tr_b16 v[38:39], v22 offset:6432
    s_waitcnt lgkmcnt(2)
    v_mfma_f32_16x16x32_bf16 v[192:195], v[32:35], v[24:27], v[192:195]
    s_waitcnt lgkmcnt(0)
    v_mfma_f32_16x16x32_bf16 v[196:199], v[36:39], v[24:27], v[196:199]
    s_waitcnt vmcnt(6)
    ds_write_b128 v10, v[72:75] offset:18432
    ds_write_b128 v16, v[76:79] offset:18432
    buffer_load_dwordx4 v[72:75], v8, s[12:15], s48 offen
    buffer_load_dwordx4 v[76:79], v12, s[16:19], s49 offen
    s_add_u32 s48, s48, 128
    s_add_u32 s49, s49, 65536
    s_waitcnt lgkmcnt(0)
    s_barrier
    ds_read_b128 v[24:27], v20 offset:18432
    ds_read_b64_tr_b16 v[32:33], v22 offset:18432
    ds_read_b64_tr_b16 v[34:35], v22 offset:19712
    ds_read_b64_tr_b16 v[36:37], v22 offset:18464
    ds_read_b64_tr_b16 v[38:39], v22 offset:19744
    s_waitcnt lgkmcnt(2)
    v_mfma_f32_16x16x32_bf16 v[192:195], v[32:35], v[24:27], v[192:195]
    s_waitcnt lgkmcnt(0)
    v_mfma_f32_16x16x32_bf16 v[196:199], v[36:39], v[24:27], v[196:199]
    ds_read_b128 v[24:27], v21 offset:18432
    ds_read_b64_tr_b16 v[32:33], v22 offset:23552
    ds_read_b64_tr_b16 v[34:35], v22 offset:24832
    ds_read_b64_tr_b16 v[36:37], v22 offset:23584
    ds_read_b64_tr_b16 v[38:39], v22 offset:24864
    s_waitcnt lgkmcnt(2)
    v_mfma_f32_16x16x32_bf16 v[192:195], v[32:35], v[24:27], v[192:195]
    s_waitcnt lgkmcnt(0)
    v_mfma_f32_16x16x32_bf16 v[196:199], v[36:39], v[24:27], v[196:199]
    s_waitcnt vmcnt(6)
    ds_write_b128 v10, v[80:83] offset:0
    ds_write_b128 v16, v[84:87] offset:0
    buffer_load_dwordx4 v[80:83], v8, s[12:15], s48 offen
    buffer_load_dwordx4 v[84:87], v12, s[16:19], s49 offen
    s_add_u32 s48, s48, 128
    s_add_u32 s49, s49, 65536
    s_waitcnt lgkmcnt(0)
    s_barrier
    ds_read_b128 v[24:27], v20 offset:0
    ds_read_b64_tr_b16 v[32:33], v22 offset:0
    ds_read_b64_tr_b16 v[34:35], v22 offset:1280
    ds_read_b64_tr_b16 v[36:37], v22 offset:32
    ds_read_b64_tr_b16 v[38:39], v22 offset:1312
    s_waitcnt lgkmcnt(2)
    v_mfma_f32_16x16x32_bf16 v[192:195], v[32:35], v[24:27], v[192:195]
    s_waitcnt lgkmcnt(0)
    v_mfma_f32_16x16x32_bf16 v[196:199], v[36:39], v[24:27], v[196:199]
    ds_read_b128 v[24:27], v21 offset:0
    ds_read_b64_tr_b16 v[32:33], v22 offset:5120
    ds_read_b64_tr_b16 v[34:35], v22 offset:6400
    ds_read_b64_tr_b16 v[36:37], v22 offset:5152
    ds_read_b64_tr_b16 v[38:39], v22 offset:6432
    s_waitcnt lgkmcnt(2)
    v_mfma_f32_16x16x32_bf16 v[192:195], v[32:35], v[24:27], v[192:195]
    s_waitcnt lgkmcnt(0)
    v_mfma_f32_16x16x32_bf16 v[196:199], v[36:39], v[24:27], v[196:199]
    s_waitcnt vmcnt(6)
    ds_write_b128 v10, v[88:91] offset:18432
    ds_write_b128 v16, v[92:95] offset:18432
    buffer_load_dwordx4 v[88:91], v8, s[12:15], s48 offen
    buffer_load_dwordx4 v[92:95], v12, s[16:19], s49 offen
    s_add_u32 s48, s48, 128
    s_add_u32 s49, s49, 65536
    s_waitcnt lgkmcnt(0)
    s_barrier
    ds_read_b128 v[24:27], v20 offset:18432
    ds_read_b64_tr_b16 v[32:33], v22 offset:18432
    ds_read_b64_tr_b16 v[34:35], v22 offset:19712
    ds_read_b64_tr_b16 v[36:37], v22 offset:18464
    ds_read_b64_tr_b16 v[38:39], v22 offset:19744
    s_waitcnt lgkmcnt(2)
    v_mfma_f32_16x16x32_bf16 v[192:195], v[32:35], v[24:27], v[192:195]
    s_waitcnt lgkmcnt(0)
    v_mfma_f32_16x16x32_bf16 v[196:199], v[36:39], v[24:27], v[196:199]
    ds_read_b128 v[24:27], v21 offset:18432
    ds_read_b64_tr_b16 v[32:33], v22 offset:23552
    ds_read_b64_tr_b16 v[34:35], v22 offset:24832
    ds_read_b64_tr_b16 v[36:37], v22 offset:23584
    ds_read_b64_tr_b16 v[38:39], v22 offset:24864
    s_waitcnt lgkmcnt(2)
    v_mfma_f32_16x16x32_bf16 v[192:195], v[32:35], v[24:27], v[192:195]
    s_waitcnt lgkmcnt(0)
    v_mfma_f32_16x16x32_bf16 v[196:199], v[36:39], v[24:27], v[196:199]
    s_waitcnt vmcnt(6)
    ds_write_b128 v10, v[64:67] offset:0
    ds_write_b128 v16, v[68:71] offset:0
    buffer_load_dwordx4 v[64:67], v8, s[12:15], s48 offen
    buffer_load_dwordx4 v[68:71], v12, s[16:19], s49 offen
    s_add_u32 s48, s48, 128
    s_add_u32 s49, s49, 65536
    s_waitcnt lgkmcnt(0)
    s_barrier
    ds_read_b128 v[24:27], v20 offset:0
    ds_read_b64_tr_b16 v[32:33], v22 offset:0
    ds_read_b64_tr_b16 v[34:35], v22 offset:1280
    ds_read_b64_tr_b16 v[36:37], v22 offset:32
    ds_read_b64_tr_b16 v[38:39], v22 offset:1312
    s_waitcnt lgkmcnt(2)
    v_mfma_f32_16x16x32_bf16 v[192:195], v[32:35], v[24:27], v[192:195]
    s_waitcnt lgkmcnt(0)
    v_mfma_f32_16x16x32_bf16 v[196:199], v[36:39], v[24:27], v[196:199]
    ds_read_b128 v[24:27], v21 offset:0
    ds_read_b64_tr_b16 v[32:33], v22 offset:5120
    ds_read_b64_tr_b16 v[34:35], v22 offset:6400
    ds_read_b64_tr_b16 v[36:37], v22 offset:5152
    ds_read_b64_tr_b16 v[38:39], v22 offset:6432
    s_waitcnt lgkmcnt(2)
    v_mfma_f32_16x16x32_bf16 v[192:195], v[32:35], v[24:27], v[192:195]
    s_waitcnt lgkmcnt(0)
    v_mfma_f32_16x16x32_bf16 v[196:199], v[36:39], v[24:27], v[196:199]
    s_waitcnt vmcnt(6)
    ds_write_b128 v10, v[72:75] offset:18432
    ds_write_b128 v16, v[76:79] offset:18432
    buffer_load_dwordx4 v[72:75], v8, s[12:15], s48 offen
    buffer_load_dwordx4 v[76:79], v12, s[16:19], s49 offen
    s_add_u32 s48, s48, 128
    s_add_u32 s49, s49, 65536
    s_waitcnt lgkmcnt(0)
    s_barrier
    ds_read_b128 v[24:27], v20 offset:18432
    ds_read_b64_tr_b16 v[32:33], v22 offset:18432
    ds_read_b64_tr_b16 v[34:35], v22 offset:19712
    ds_read_b64_tr_b16 v[36:37], v22 offset:18464
    ds_read_b64_tr_b16 v[38:39], v22 offset:19744
    s_waitcnt lgkmcnt(2)
    v_mfma_f32_16x16x32_bf16 v[192:195], v[32:35], v[24:27], v[192:195]
    s_waitcnt lgkmcnt(0)
    v_mfma_f32_16x16x32_bf16 v[196:199], v[36:39], v[24:27], v[196:199]
    ds_read_b128 v[24:27], v21 offset:18432
    ds_read_b64_tr_b16 v[32:33], v22 offset:23552
    ds_read_b64_tr_b16 v[34:35], v22 offset:24832
    ds_read_b64_tr_b16 v[36:37], v22 offset:23584
    ds_read_b64_tr_b16 v[38:39], v22 offset:24864
    s_waitcnt lgkmcnt(2)
    v_mfma_f32_16x16x32_bf16 v[192:195], v[32:35], v[24:27], v[192:195]
    s_waitcnt lgkmcnt(0)
    v_mfma_f32_16x16x32_bf16 v[196:199], v[36:39], v[24:27], v[196:199]
    s_waitcnt vmcnt(6)
    ds_write_b128 v10, v[80:83] offset:0
    ds_write_b128 v16, v[84:87] offset:0
    buffer_load_dwordx4 v[80:83], v8, s[12:15], s48 offen
    buffer_load_dwordx4 v[84:87], v12, s[16:19], s49 offen
    s_add_u32 s48, s48, 128
    s_add_u32 s49, s49, 65536
    s_waitcnt lgkmcnt(0)
    s_barrier
    ds_read_b128 v[24:27], v20 offset:0
    ds_read_b64_tr_b16 v[32:33], v22 offset:0
    ds_read_b64_tr_b16 v[34:35], v22 offset:1280
    ds_read_b64_tr_b16 v[36:37], v22 offset:32
    ds_read_b64_tr_b16 v[38:39], v22 offset:1312
    s_waitcnt lgkmcnt(2)
    v_mfma_f32_16x16x32_bf16 v[192:195], v[32:35], v[24:27], v[192:195]
    s_waitcnt lgkmcnt(0)
    v_mfma_f32_16x16x32_bf16 v[196:199], v[36:39], v[24:27], v[196:199]
    ds_read_b128 v[24:27], v21 offset:0
    ds_read_b64_tr_b16 v[32:33], v22 offset:5120
    ds_read_b64_tr_b16 v[34:35], v22 offset:6400
    ds_read_b64_tr_b16 v[36:37], v22 offset:5152
    ds_read_b64_tr_b16 v[38:39], v22 offset:6432
    s_waitcnt lgkmcnt(2)
    v_mfma_f32_16x16x32_bf16 v[192:195], v[32:35], v[24:27], v[192:195]
    s_waitcnt lgkmcnt(0)
    v_mfma_f32_16x16x32_bf16 v[196:199], v[36:39], v[24:27], v[196:199]
    s_waitcnt vmcnt(6)
    ds_write_b128 v10, v[88:91] offset:18432
    ds_write_b128 v16, v[92:95] offset:18432
    buffer_load_dwordx4 v[88:91], v8, s[12:15], s48 offen
    buffer_load_dwordx4 v[92:95], v12, s[16:19], s49 offen
    s_add_u32 s48, s48, 128
    s_add_u32 s49, s49, 65536
    s_waitcnt lgkmcnt(0)
    s_barrier
    ds_read_b128 v[24:27], v20 offset:18432
    ds_read_b64_tr_b16 v[32:33], v22 offset:18432
    ds_read_b64_tr_b16 v[34:35], v22 offset:19712
    ds_read_b64_tr_b16 v[36:37], v22 offset:18464
    ds_read_b64_tr_b16 v[38:39], v22 offset:19744
    s_waitcnt lgkmcnt(2)
    v_mfma_f32_16x16x32_bf16 v[192:195], v[32:35], v[24:27], v[192:195]
    s_waitcnt lgkmcnt(0)
    v_mfma_f32_16x16x32_bf16 v[196:199], v[36:39], v[24:27], v[196:199]
    ds_read_b128 v[24:27], v21 offset:18432
    ds_read_b64_tr_b16 v[32:33], v22 offset:23552
    ds_read_b64_tr_b16 v[34:35], v22 offset:24832
    ds_read_b64_tr_b16 v[36:37], v22 offset:23584
    ds_read_b64_tr_b16 v[38:39], v22 offset:24864
    s_waitcnt lgkmcnt(2)
    v_mfma_f32_16x16x32_bf16 v[192:195], v[32:35], v[24:27], v[192:195]
    s_waitcnt lgkmcnt(0)
    v_mfma_f32_16x16x32_bf16 v[196:199], v[36:39], v[24:27], v[196:199]
    s_waitcnt vmcnt(6)
    ds_write_b128 v10, v[64:67] offset:0
    ds_write_b128 v16, v[68:71] offset:0
    buffer_load_dwordx4 v[64:67], v8, s[12:15], s48 offen
    buffer_load_dwordx4 v[68:71], v12, s[16:19], s49 offen
    s_add_u32 s48, s48, 128
    s_add_u32 s49, s49, 65536
    s_waitcnt lgkmcnt(0)
    s_barrier
    ds_read_b128 v[24:27], v20 offset:0
    ds_read_b64_tr_b16 v[32:33], v22 offset:0
    ds_read_b64_tr_b16 v[34:35], v22 offset:1280
    ds_read_b64_tr_b16 v[36:37], v22 offset:32
    ds_read_b64_tr_b16 v[38:39], v22 offset:1312
    s_waitcnt lgkmcnt(2)
    v_mfma_f32_16x16x32_bf16 v[192:195], v[32:35], v[24:27], v[192:195]
    s_waitcnt lgkmcnt(0)
    v_mfma_f32_16x16x32_bf16 v[196:199], v[36:39], v[24:27], v[196:199]
    ds_read_b128 v[24:27], v21 offset:0
    ds_read_b64_tr_b16 v[32:33], v22 offset:5120
    ds_read_b64_tr_b16 v[34:35], v22 offset:6400
    ds_read_b64_tr_b16 v[36:37], v22 offset:5152
    ds_read_b64_tr_b16 v[38:39], v22 offset:6432
    s_waitcnt lgkmcnt(2)
    v_mfma_f32_16x16x32_bf16 v[192:195], v[32:35], v[24:27], v[192:195]
    s_waitcnt lgkmcnt(0)
    v_mfma_f32_16x16x32_bf16 v[196:199], v[36:39], v[24:27], v[196:199]
    s_waitcnt vmcnt(6)
    ds_write_b128 v10, v[72:75] offset:18432
    ds_write_b128 v16, v[76:79] offset:18432
    buffer_load_dwordx4 v[72:75], v8, s[12:15], s48 offen
    buffer_load_dwordx4 v[76:79], v12, s[16:19], s49 offen
    s_add_u32 s48, s48, 128
    s_add_u32 s49, s49, 65536
    s_waitcnt lgkmcnt(0)
    s_barrier
    ds_read_b128 v[24:27], v20 offset:18432
    ds_read_b64_tr_b16 v[32:33], v22 offset:18432
    ds_read_b64_tr_b16 v[34:35], v22 offset:19712
    ds_read_b64_tr_b16 v[36:37], v22 offset:18464
    ds_read_b64_tr_b16 v[38:39], v22 offset:19744
    s_waitcnt lgkmcnt(2)
    v_mfma_f32_16x16x32_bf16 v[192:195], v[32:35], v[24:27], v[192:195]
    s_waitcnt lgkmcnt(0)
    v_mfma_f32_16x16x32_bf16 v[196:199], v[36:39], v[24:27], v[196:199]
    ds_read_b128 v[24:27], v21 offset:18432
    ds_read_b64_tr_b16 v[32:33], v22 offset:23552
    ds_read_b64_tr_b16 v[34:35], v22 offset:24832
    ds_read_b64_tr_b16 v[36:37], v22 offset:23584
    ds_read_b64_tr_b16 v[38:39], v22 offset:24864
    s_waitcnt lgkmcnt(2)
    v_mfma_f32_16x16x32_bf16 v[192:195], v[32:35], v[24:27], v[192:195]
    s_waitcnt lgkmcnt(0)
    v_mfma_f32_16x16x32_bf16 v[196:199], v[36:39], v[24:27], v[196:199]
    s_waitcnt vmcnt(6)
    ds_write_b128 v10, v[80:83] offset:0
    ds_write_b128 v16, v[84:87] offset:0
    buffer_load_dwordx4 v[80:83], v8, s[12:15], s48 offen
    buffer_load_dwordx4 v[84:87], v12, s[16:19], s49 offen
    s_add_u32 s48, s48, 128
    s_add_u32 s49, s49, 65536
    s_waitcnt lgkmcnt(0)
    s_barrier
    s_nop 7
    s_lshr_b32 s37, s30, 1
    s_lshl_b32 s37, s37, 4
    s_add_u32 s37, s37, s28
    s_and_b32 s38, s30, 1
    s_mul_i32 s38, s38, 32
    s_add_u32 s38, s38, s29
    v_add_u32 v7, s37, v4
    s_mov_b32 s34, 1024
    v_mul_u32_u24 v5, s34, v7
    v_lshl_add_u32 v6, v3, 2, s38
    v_lshl_add_u32 v5, v6, 1, v5
    s_mov_b32 s42, 0
    s_mov_b32 s43, 16384
    s_waitcnt vmcnt(0)
    buffer_load_dwordx2 v[64:65], v5, s[20:23], s42 offen offset:0
    buffer_load_dwordx2 v[66:67], v5, s[20:23], s42 offen offset:32
    s_waitcnt vmcnt(0)
    v_cvt_pk_bf16_f32 v192, v192, v193
    v_cvt_pk_bf16_f32 v194, v194, v195
    v_and_b32 v193, 0xffff0000, v192
    v_lshlrev_b32 v192, 16, v192
    v_and_b32 v25, 0xffff0000, v64
    v_lshlrev_b32 v24, 16, v64
    v_add_f32 v192, v192, v24
    v_add_f32 v193, v193, v25
    v_cvt_pk_bf16_f32 v64, v192, v193
    v_and_b32 v195, 0xffff0000, v194
    v_lshlrev_b32 v194, 16, v194
    v_and_b32 v25, 0xffff0000, v65
    v_lshlrev_b32 v24, 16, v65
    v_add_f32 v194, v194, v24
    v_add_f32 v195, v195, v25
    v_cvt_pk_bf16_f32 v65, v194, v195
    buffer_store_dwordx2 v[64:65], v5, s[24:27], s42 offen offset:0
    v_cvt_pk_bf16_f32 v196, v196, v197
    v_cvt_pk_bf16_f32 v198, v198, v199
    v_and_b32 v197, 0xffff0000, v196
    v_lshlrev_b32 v196, 16, v196
    v_and_b32 v25, 0xffff0000, v66
    v_lshlrev_b32 v24, 16, v66
    v_add_f32 v196, v196, v24
    v_add_f32 v197, v197, v25
    v_cvt_pk_bf16_f32 v66, v196, v197
    v_and_b32 v199, 0xffff0000, v198
    v_lshlrev_b32 v198, 16, v198
    v_and_b32 v25, 0xffff0000, v67
    v_lshlrev_b32 v24, 16, v67
    v_add_f32 v198, v198, v24
    v_add_f32 v199, v199, v25
    v_cvt_pk_bf16_f32 v67, v198, v199
    buffer_store_dwordx2 v[66:67], v5, s[24:27], s42 offen offset:32
k7_wout_kernel_end:
    s_endpgm

.section .rodata,"a"
.p2align 6
.amdhsa_kernel k1_qkv_kernel
  .amdhsa_next_free_vgpr 248
  .amdhsa_next_free_sgpr 102
  .amdhsa_accum_offset 248
  .amdhsa_group_segment_fixed_size 0
  .amdhsa_kernarg_size 88
  .amdhsa_user_sgpr_count 2
  .amdhsa_user_sgpr_kernarg_segment_ptr 1
  .amdhsa_system_sgpr_workgroup_id_x 1
.end_amdhsa_kernel

.p2align 6
.amdhsa_kernel k2_attn_kernel
  .amdhsa_next_free_vgpr 168
  .amdhsa_next_free_sgpr 102
  .amdhsa_accum_offset 168
  .amdhsa_group_segment_fixed_size 0
  .amdhsa_kernarg_size 88
  .amdhsa_user_sgpr_count 2
  .amdhsa_user_sgpr_kernarg_segment_ptr 1
  .amdhsa_system_sgpr_workgroup_id_x 1
.end_amdhsa_kernel

.p2align 6
.amdhsa_kernel k3_wo_kernel
  .amdhsa_next_free_vgpr 256
  .amdhsa_next_free_sgpr 102
  .amdhsa_accum_offset 256
  .amdhsa_group_segment_fixed_size 0
  .amdhsa_kernarg_size 88
  .amdhsa_user_sgpr_count 2
  .amdhsa_user_sgpr_kernarg_segment_ptr 1
  .amdhsa_system_sgpr_workgroup_id_x 1
.end_amdhsa_kernel

.p2align 6
.amdhsa_kernel k4_win_kernel
  .amdhsa_next_free_vgpr 248
  .amdhsa_next_free_sgpr 102
  .amdhsa_accum_offset 248
  .amdhsa_group_segment_fixed_size 0
  .amdhsa_kernarg_size 88
  .amdhsa_user_sgpr_count 2
  .amdhsa_user_sgpr_kernarg_segment_ptr 1
  .amdhsa_system_sgpr_workgroup_id_x 1
.end_amdhsa_kernel

.p2align 6
.amdhsa_kernel k5_lnt_kernel
  .amdhsa_next_free_vgpr 96
  .amdhsa_next_free_sgpr 102
  .amdhsa_accum_offset 96
  .amdhsa_group_segment_fixed_size 0
  .amdhsa_kernarg_size 88
  .amdhsa_user_sgpr_count 2
  .amdhsa_user_sgpr_kernarg_segment_ptr 1
  .amdhsa_system_sgpr_workgroup_id_x 1
.end_amdhsa_kernel

.p2align 6
.amdhsa_kernel k6_wsp_kernel
  .amdhsa_next_free_vgpr 256
  .amdhsa_next_free_sgpr 102
  .amdhsa_accum_offset 256
  .amdhsa_group_segment_fixed_size 0
  .amdhsa_kernarg_size 88
  .amdhsa_user_sgpr_count 2
  .amdhsa_user_sgpr_kernarg_segment_ptr 1
  .amdhsa_system_sgpr_workgroup_id_x 1
.end_amdhsa_kernel

.p2align 6
.amdhsa_kernel k7_wout_kernel
  .amdhsa_next_free_vgpr 256
  .amdhsa_next_free_sgpr 102
  .amdhsa_accum_offset 256
  .amdhsa_group_segment_fixed_size 0
  .amdhsa_kernarg_size 88
  .amdhsa_user_sgpr_count 2
  .amdhsa_user_sgpr_kernarg_segment_ptr 1
  .amdhsa_system_sgpr_workgroup_id_x 1
.end_amdhsa_kernel
```
